```python
import torch

def _softmax(x, axis=-1):
    return torch.softmax(x, dim=axis)
def _gelu(x):
    return torch.nn.functional.gelu(x, approximate="tanh")
def _silu(x):
    return torch.nn.functional.silu(x)
def _sigmoid(x):
    return torch.sigmoid(x)
def _layernorm(x, axis=-1, eps=1e-5):
    m = x.mean(dim=axis, keepdim=True)
    v = x.var(dim=axis, keepdim=True, unbiased=False)
    return (x - m) / torch.sqrt(v + eps)
def _scatter_add(tgt, idx, src, axis=0):
    return tgt.clone().index_add_(axis, idx, src)
def _segment_sum(src, seg, n):
    out = torch.zeros((n,) + src.shape[1:], dtype=src.dtype)
    return out.index_add_(0, seg, src)
def _pad(x, pw):
    flat = tuple(v for pair in reversed(pw) for v in pair)
    return torch.nn.functional.pad(x, flat)

kernel_name = 'concat_heads__gqa_block_cached__gqa_block_cached__near_ridge'

def setup_inputs():

    _w = (lambda a: (lambda t: t.to(torch.bfloat16) if t.is_floating_point() else t)(torch.as_tensor(a)))
    def _A_setup():
        B, Sq, D = 8, 48, 512
        Hq, Hkv, Sk, Dh = 32, 8, 1024, 128
        assert Hq % Hkv == 0, (Hq, Hkv)
        return {
            "x": _w((lambda *s: torch.randn(*s, dtype=torch.bfloat16) * 0.8)(B, Sq, D)),
            "k_cache": _w((lambda *s: torch.randn(*s, dtype=torch.bfloat16) * 0.8)(B, Hkv, Sk, Dh)),
            "v_cache": _w((lambda *s: torch.randn(*s, dtype=torch.bfloat16) * 0.05)(B, Hkv, Sk, Dh)),
            "wq": _w((lambda *s: torch.randn(*s, dtype=torch.bfloat16) * 0.8)(D, Hq * Dh) * (D ** -0.5)),
            "wo": _w((lambda *s: torch.randn(*s, dtype=torch.bfloat16) * 0.05)(Hq * Dh, D) * ((Hq * Dh) ** -0.5)),
        }
    _A_in = _A_setup()

    def _B_setup():
        B, Sq, D = 8, 48, 512
        Hq, Hkv, Sk, Dh = 32, 8, 1024, 128
        assert Hq % Hkv == 0, (Hq, Hkv)
        return {
            "x": _w((lambda *s: torch.randn(*s, dtype=torch.bfloat16) * 0.8)(B, Sq, D)),
            "k_cache": _w((lambda *s: torch.randn(*s, dtype=torch.bfloat16) * 0.8)(B, Hkv, Sk, Dh)),
            "v_cache": _w((lambda *s: torch.randn(*s, dtype=torch.bfloat16) * 0.05)(B, Hkv, Sk, Dh)),
            "wq": _w((lambda *s: torch.randn(*s, dtype=torch.bfloat16) * 0.8)(D, Hq * Dh) * (D ** -0.5)),
            "wo": _w((lambda *s: torch.randn(*s, dtype=torch.bfloat16) * 0.05)(Hq * Dh, D) * ((Hq * Dh) ** -0.5)),
        }
    _B_in = _B_setup()

    return {
        "A_x": _A_in["x"],
        "A_k_cache": _A_in["k_cache"],
        "A_v_cache": _A_in["v_cache"],
        "A_wq": _A_in["wq"],
        "A_wo": _A_in["wo"],
        "B_x": _B_in["x"],
        "B_k_cache": _B_in["k_cache"],
        "B_v_cache": _B_in["v_cache"],
        "B_wq": _B_in["wq"],
        "B_wo": _B_in["wo"],
    }

def reference(A_x, A_k_cache, A_v_cache, A_wq, A_wo, B_x, B_k_cache, B_v_cache, B_wq, B_wo):
    def _A_ref(x, k_cache, v_cache, wq, wo):
        B, Sq, D = x.shape
        Hq, Dh = 32, 128
        Hkv = k_cache.shape[1]
        rep = Hq // Hkv
        q = (lambda x, *d: x.permute(*d))((x @ wq).reshape(B, Sq, Hq, Dh), 0, 2, 1, 3)
        k = (lambda x, n, axis: torch.repeat_interleave(x, n, dim=axis))(k_cache, rep, axis=1)
        v = (lambda x, n, axis: torch.repeat_interleave(x, n, dim=axis))(v_cache, rep, axis=1)
        scores = torch.einsum("bhqd,bhkd->bhqk", q, k) * (Dh ** -0.5)
        p = _softmax(scores, axis=-1)
        o = torch.einsum("bhqk,bhkd->bhqd", p, v)
        return (lambda x, *d: x.permute(*d))(o, 0, 2, 1, 3).reshape(B, Sq, Hq * Dh) @ wo

    def _B_ref(x, k_cache, v_cache, wq, wo):
        B, Sq, D = x.shape
        Hq, Dh = 32, 128
        Hkv = k_cache.shape[1]
        rep = Hq // Hkv
        q = (lambda x, *d: x.permute(*d))((x @ wq).reshape(B, Sq, Hq, Dh), 0, 2, 1, 3)
        k = (lambda x, n, axis: torch.repeat_interleave(x, n, dim=axis))(k_cache, rep, axis=1)
        v = (lambda x, n, axis: torch.repeat_interleave(x, n, dim=axis))(v_cache, rep, axis=1)
        scores = torch.einsum("bhqd,bhkd->bhqk", q, k) * (Dh ** -0.5)
        p = _softmax(scores, axis=-1)
        o = torch.einsum("bhqk,bhkd->bhqd", p, v)
        return (lambda x, *d: x.permute(*d))(o, 0, 2, 1, 3).reshape(B, Sq, Hq * Dh) @ wo

    a = _A_ref(A_x, A_k_cache, A_v_cache, A_wq, A_wo)
    b = _B_ref(B_x, B_k_cache, B_v_cache, B_wq, B_wo)
    return torch.concatenate([a, b], axis=-1)
```

```asm
; @launch grid=(256,1,1) block=(512,1,1) lds=163840
.amdgcn_target "amdgcn-amd-amdhsa--gfx950"
.text
.globl concat_heads__gqa_block_cached__gqa_block_cached__near_ridge_kernel
.p2align 8
.type concat_heads__gqa_block_cached__gqa_block_cached__near_ridge_kernel,@function
concat_heads__gqa_block_cached__gqa_block_cached__near_ridge_kernel:
    s_cmp_ge_u32 s2, 256
    s_cbranch_scc1 L_end
    s_load_dwordx16 s[32:47], s[0:1], 0
    s_load_dwordx4 s[48:51], s[0:1], 64
    s_load_dwordx2 s[52:53], s[0:1], 96
    s_load_dwordx2 s[96:97], s[0:1], 80
    s_load_dwordx2 s[94:95], s[0:1], 88
    v_and_b32 v1, 63, v0
    v_lshrrev_b32 v2, 6, v0
    s_and_b32 s54, s2, 7
    v_readfirstlane_b32 s3, v2
    s_lshr_b32 s60, s2, 3
    s_and_b32 s55, s60, 1
    s_lshr_b32 s56, s60, 1
    s_and_b32 s56, s56, 7
    s_lshr_b32 s57, s60, 4
    s_lshl_b32 s93, s54, 1
    s_add_u32 s93, s93, s55
    s_lshl_b32 s92, s57, 3
    s_add_u32 s92, s92, s56
    s_lshl_b32 s58, s56, 1
    s_lshl_b32 s60, s55, 3
    s_add_u32 s58, s58, s60
    s_and_b32 s58, s58, 15
    s_mov_b32 s31, s56
    s_cmp_ge_u32 s3, 4
    s_cbranch_scc1 L_loader
    v_lshrrev_b32 v9, 4, v1
    v_and_b32 v15, 15, v1
    v_xor_b32 v12, v9, v15
    v_lshlrev_b32_e64 v12, 4, v12
    v_lshl_add_u32 v2, v15, 8, v12
    s_lshl_b32 s59, s3, 14
    s_add_u32 s59, s59, 16384
    v_bfe_u32 v13, v1, 2, 2
    v_and_b32 v15, 3, v1
    v_and_b32 v14, 2, v13
    v_and_b32 v12, 1, v9
    v_lshl_or_b32 v14, v12, 2, v14
    v_lshrrev_b32 v12, 1, v15
    v_or_b32 v14, v14, v12
    v_lshlrev_b32 v14, 4, v14
    v_and_b32 v12, 1, v15
    v_lshl_add_u32 v14, v12, 3, v14
    v_lshl_add_u32 v12, v9, 3, v13
    v_lshl_add_u32 v14, v12, 7, v14
    v_add_u32 v14, s59, v14
    v_xor_b32 v5, 0, v14
    v_xor_b32 v6, 32, v14
    v_xor_b32 v7, 64, v14
    v_xor_b32 v8, 96, v14
    s_add_u32 s60, s58, 0
    s_and_b32 s60, s60, 15
    s_and_b32 s61, s60, 3
    s_lshl_b32 s61, s61, 6
    s_lshr_b32 s60, s60, 2
    s_mul_i32 s60, s60, 12288
    s_add_u32 s60, s60, 114688
    v_xor_b32 v3, s61, v2
    v_add_u32 v3, s60, v3
    s_add_u32 s60, s58, 1
    s_and_b32 s60, s60, 15
    s_and_b32 s61, s60, 3
    s_lshl_b32 s61, s61, 6
    s_lshr_b32 s60, s60, 2
    s_mul_i32 s60, s60, 12288
    s_add_u32 s60, s60, 114688
    v_xor_b32 v4, s61, v2
    v_add_u32 v4, s60, v4
    s_waitcnt lgkmcnt(0)
    s_barrier
    ds_read_b128 a[32:35], v3 offset:0
    ds_read_b128 a[36:39], v3 offset:4096
    ds_read_b128 a[40:43], v3 offset:8192
    ds_read_b64_tr_b16 a[0:1], v5 offset:0
    ds_read_b64_tr_b16 a[2:3], v5 offset:512
    ds_read_b64_tr_b16 a[4:5], v6 offset:0
    ds_read_b64_tr_b16 a[6:7], v6 offset:512
    ds_read_b64_tr_b16 a[8:9], v7 offset:0
    ds_read_b64_tr_b16 a[10:11], v7 offset:512
    ds_read_b64_tr_b16 a[12:13], v8 offset:0
    ds_read_b64_tr_b16 a[14:15], v8 offset:512
    s_waitcnt lgkmcnt(6)
    v_mfma_f32_16x16x32_bf16 v[32:35], a[0:3], a[32:35], 0
    ds_read_b128 a[44:47], v4 offset:0
    ds_read_b128 a[48:51], v4 offset:4096
    v_mfma_f32_16x16x32_bf16 v[36:39], a[0:3], a[36:39], 0
    ds_read_b128 a[52:55], v4 offset:8192
    v_mfma_f32_16x16x32_bf16 v[40:43], a[0:3], a[40:43], 0
    ds_read_b64_tr_b16 a[16:17], v5 offset:4096
    s_waitcnt lgkmcnt(8)
    v_mfma_f32_16x16x32_bf16 v[44:47], a[4:7], a[32:35], 0
    ds_read_b64_tr_b16 a[18:19], v5 offset:4608
    v_mfma_f32_16x16x32_bf16 v[48:51], a[4:7], a[36:39], 0
    ds_read_b64_tr_b16 a[20:21], v6 offset:4096
    ds_read_b64_tr_b16 a[22:23], v6 offset:4608
    v_mfma_f32_16x16x32_bf16 v[52:55], a[4:7], a[40:43], 0
    ds_read_b64_tr_b16 a[24:25], v7 offset:4096
    s_waitcnt lgkmcnt(10)
    v_mfma_f32_16x16x32_bf16 v[56:59], a[8:11], a[32:35], 0
    ds_read_b64_tr_b16 a[26:27], v7 offset:4608
    v_mfma_f32_16x16x32_bf16 v[60:63], a[8:11], a[36:39], 0
    ds_read_b64_tr_b16 a[28:29], v8 offset:4096
    v_mfma_f32_16x16x32_bf16 v[64:67], a[8:11], a[40:43], 0
    ds_read_b64_tr_b16 a[30:31], v8 offset:4608
    s_waitcnt lgkmcnt(11)
    v_mfma_f32_16x16x32_bf16 v[68:71], a[12:15], a[32:35], 0
    s_add_u32 s60, s58, 2
    s_and_b32 s60, s60, 15
    s_and_b32 s61, s60, 3
    s_lshl_b32 s61, s61, 6
    s_lshr_b32 s60, s60, 2
    s_mul_i32 s60, s60, 12288
    s_add_u32 s60, s60, 114688
    v_xor_b32 v3, s61, v2
    v_add_u32_e64 v3, s60, v3
    v_mfma_f32_16x16x32_bf16 v[72:75], a[12:15], a[36:39], 0
    v_mfma_f32_16x16x32_bf16 v[76:79], a[12:15], a[40:43], 0
    s_mov_b32 s67, 0x49800000
    s_mov_b32 s30, 0x35800000
    s_mov_b32 s68, 0x3e0293ee
    s_mov_b32 s69, 0x3e0293ee
    v_lshrrev_b32 v92, 4, v1
    v_and_b32 v93, 15, v1
    s_and_b32 s62, s3, 1
    s_lshl_b32 s62, s62, 3
    v_lshrrev_b32 v94, 1, v92
    v_xor_b32 v94, v94, v93
    v_xor_b32 v94, s62, v94
    v_lshlrev_b32 v94, 4, v94
    v_and_b32_e64 v92, 1, v92
    s_barrier
    s_waitcnt lgkmcnt(6)
    v_mfma_f32_16x16x32_bf16 v[32:35], a[16:19], a[44:47], v[32:35]
    ds_read_b128 a[32:35], v3 offset:0
    ds_read_b128 a[36:39], v3 offset:4096
    v_mfma_f32_16x16x32_bf16 v[36:39], a[16:19], a[48:51], v[36:39]
    ds_read_b128 a[40:43], v3 offset:8192
    v_mfma_f32_16x16x32_bf16 v[40:43], a[16:19], a[52:55], v[40:43]
    ds_read_b64_tr_b16 a[0:1], v5 offset:8192
    s_waitcnt lgkmcnt(8)
    v_mfma_f32_16x16x32_bf16 v[44:47], a[20:23], a[44:47], v[44:47]
    ds_read_b64_tr_b16 a[2:3], v5 offset:8704
    v_mfma_f32_16x16x32_bf16 v[48:51], a[20:23], a[48:51], v[48:51]
    ds_read_b64_tr_b16 a[4:5], v6 offset:8192
    ds_read_b64_tr_b16 a[6:7], v6 offset:8704
    v_mfma_f32_16x16x32_bf16 v[52:55], a[20:23], a[52:55], v[52:55]
    ds_read_b64_tr_b16 a[8:9], v7 offset:8192
    s_waitcnt lgkmcnt(10)
    v_mfma_f32_16x16x32_bf16 v[56:59], a[24:27], a[44:47], v[56:59]
    ds_read_b64_tr_b16 a[10:11], v7 offset:8704
    v_mfma_f32_16x16x32_bf16 v[60:63], a[24:27], a[48:51], v[60:63]
    ds_read_b64_tr_b16 a[12:13], v8 offset:8192
    v_mfma_f32_16x16x32_bf16 v[64:67], a[24:27], a[52:55], v[64:67]
    ds_read_b64_tr_b16 a[14:15], v8 offset:8704
    s_waitcnt lgkmcnt(11)
    v_mfma_f32_16x16x32_bf16 v[68:71], a[28:31], a[44:47], v[68:71]
    s_add_u32 s60, s58, 3
    s_and_b32 s60, s60, 15
    s_and_b32 s61, s60, 3
    s_lshl_b32 s61, s61, 6
    s_lshr_b32 s60, s60, 2
    s_mul_i32 s60, s60, 12288
    s_add_u32 s60, s60, 114688
    v_xor_b32 v4, s61, v2
    v_add_u32 v4, s60, v4
    v_mfma_f32_16x16x32_bf16 v[72:75], a[28:31], a[48:51], v[72:75]
    v_mfma_f32_16x16x32_bf16 v[76:79], a[28:31], a[52:55], v[76:79]
    v_lshl_add_u32 v94, v92, 3, v94
    s_lshr_b32 s62, s3, 1
    s_mul_i32 s62, s62, 12288
    s_add_u32 s62, s62, 114688
    v_lshl_add_u32 v94, v93, 8, v94
    v_add_u32 v94, s62, v94
    v_xor_b32 v88, 0, v94
    v_xor_b32 v89, 32, v94
    v_xor_b32_e64 v90, 64, v94
    v_xor_b32 v91, 96, v94
    v_and_b32 v92, 31, v1
    v_lshrrev_b32 v93, 5, v1
    v_and_b32 v94, 15, v1
    v_xor_b32 v94, v94, v93
    s_barrier
    s_waitcnt lgkmcnt(6)
    v_mfma_f32_16x16x32_bf16 v[32:35], a[0:3], a[32:35], v[32:35]
    ds_read_b128 a[44:47], v4 offset:0
    ds_read_b128 a[48:51], v4 offset:4096
    v_mfma_f32_16x16x32_bf16 v[36:39], a[0:3], a[36:39], v[36:39]
    ds_read_b128 a[52:55], v4 offset:8192
    v_mfma_f32_16x16x32_bf16 v[40:43], a[0:3], a[40:43], v[40:43]
    ds_read_b64_tr_b16 a[16:17], v5 offset:12288
    s_waitcnt lgkmcnt(8)
    v_mfma_f32_16x16x32_bf16 v[44:47], a[4:7], a[32:35], v[44:47]
    ds_read_b64_tr_b16 a[18:19], v5 offset:12800
    v_mfma_f32_16x16x32_bf16 v[48:51], a[4:7], a[36:39], v[48:51]
    ds_read_b64_tr_b16 a[20:21], v6 offset:12288
    ds_read_b64_tr_b16 a[22:23], v6 offset:12800
    v_mfma_f32_16x16x32_bf16 v[52:55], a[4:7], a[40:43], v[52:55]
    ds_read_b64_tr_b16 a[24:25], v7 offset:12288
    s_waitcnt lgkmcnt(10)
    v_mfma_f32_16x16x32_bf16 v[56:59], a[8:11], a[32:35], v[56:59]
    ds_read_b64_tr_b16 a[26:27], v7 offset:12800
    v_mfma_f32_16x16x32_bf16 v[60:63], a[8:11], a[36:39], v[60:63]
    ds_read_b64_tr_b16 a[28:29], v8 offset:12288
    v_mfma_f32_16x16x32_bf16 v[64:67], a[8:11], a[40:43], v[64:67]
    ds_read_b64_tr_b16 a[30:31], v8 offset:12800
    s_waitcnt lgkmcnt(11)
    v_mfma_f32_16x16x32_bf16 v[68:71], a[12:15], a[32:35], v[68:71]
    s_add_u32 s60, s58, 4
    s_and_b32 s60, s60, 15
    s_and_b32 s61, s60, 3
    s_lshl_b32 s61, s61, 6
    s_lshr_b32 s60, s60, 2
    s_mul_i32 s60, s60, 12288
    s_add_u32 s60, s60, 114688
    v_xor_b32 v3, s61, v2
    v_add_u32 v3, s60, v3
    v_mfma_f32_16x16x32_bf16 v[72:75], a[12:15], a[36:39], v[72:75]
    v_mfma_f32_16x16x32_bf16 v[76:79], a[12:15], a[40:43], v[76:79]
    v_lshlrev_b32_e64 v94, 4, v94
    v_lshl_add_u32 v94, v92, 8, v94
    v_add_u32 v94, 65536, v94
    v_xor_b32 v16, 0, v94
    v_xor_b32 v17, 32, v94
    v_xor_b32_e64 v18, 64, v94
    v_xor_b32 v19, 96, v94
    v_xor_b32 v20, 128, v94
    v_xor_b32 v21, 160, v94
    v_xor_b32 v22, 192, v94
    v_xor_b32 v23, 224, v94
    s_lshl_b32 s62, s3, 13
    s_add_u32 s62, s62, 49152
    v_add_u32 v80, s62, v16
    s_barrier
    s_waitcnt lgkmcnt(6)
    v_mfma_f32_16x16x32_bf16 v[32:35], a[16:19], a[44:47], v[32:35]
    ds_read_b128 a[32:35], v3 offset:0
    ds_read_b128 a[36:39], v3 offset:4096
    v_mfma_f32_16x16x32_bf16 v[36:39], a[16:19], a[48:51], v[36:39]
    ds_read_b128 a[40:43], v3 offset:8192
    v_mfma_f32_16x16x32_bf16 v[40:43], a[16:19], a[52:55], v[40:43]
    ds_read_b64_tr_b16 a[0:1], v5 offset:0
    s_waitcnt lgkmcnt(8)
    v_mfma_f32_16x16x32_bf16 v[44:47], a[20:23], a[44:47], v[44:47]
    ds_read_b64_tr_b16 a[2:3], v5 offset:512
    v_mfma_f32_16x16x32_bf16 v[48:51], a[20:23], a[48:51], v[48:51]
    ds_read_b64_tr_b16 a[4:5], v6 offset:0
    ds_read_b64_tr_b16 a[6:7], v6 offset:512
    v_mfma_f32_16x16x32_bf16 v[52:55], a[20:23], a[52:55], v[52:55]
    ds_read_b64_tr_b16 a[8:9], v7 offset:0
    s_waitcnt lgkmcnt(10)
    v_mfma_f32_16x16x32_bf16 v[56:59], a[24:27], a[44:47], v[56:59]
    ds_read_b64_tr_b16 a[10:11], v7 offset:512
    v_mfma_f32_16x16x32_bf16 v[60:63], a[24:27], a[48:51], v[60:63]
    ds_read_b64_tr_b16 a[12:13], v8 offset:0
    v_mfma_f32_16x16x32_bf16 v[64:67], a[24:27], a[52:55], v[64:67]
    ds_read_b64_tr_b16 a[14:15], v8 offset:512
    s_waitcnt lgkmcnt(11)
    v_mfma_f32_16x16x32_bf16 v[68:71], a[28:31], a[44:47], v[68:71]
    s_add_u32 s60, s58, 5
    s_and_b32 s60, s60, 15
    s_and_b32 s61, s60, 3
    s_lshl_b32 s61, s61, 6
    s_lshr_b32 s60, s60, 2
    s_mul_i32 s60, s60, 12288
    s_add_u32 s60, s60, 114688
    v_xor_b32 v4, s61, v2
    v_add_u32 v4, s60, v4
    v_mfma_f32_16x16x32_bf16 v[72:75], a[28:31], a[48:51], v[72:75]
    v_mfma_f32_16x16x32_bf16 v[76:79], a[28:31], a[52:55], v[76:79]
    v_add_u32 v81, s62, v17
    v_add_u32 v82, s62, v18
    v_add_u32 v83, s62, v19
    v_add_u32 v84, s62, v20
    v_add_u32 v85, s62, v21
    v_add_u32 v86, s62, v22
    v_add_u32_e64 v87, s62, v23
    v_bfe_u32 v92, v1, 2, 2
    v_lshl_add_u32 v94, v93, 2, v92
    v_lshlrev_b32_e64 v94, 8, v94
    v_lshl_add_u32 v94, v92, 6, v94
    v_bfe_u32 v95, v1, 4, 1
    v_lshl_add_u32 v94, v95, 5, v94
    s_barrier
    s_waitcnt lgkmcnt(6)
    v_mfma_f32_16x16x32_bf16 v[32:35], a[0:3], a[32:35], v[32:35]
    ds_read_b128 a[44:47], v4 offset:0
    ds_read_b128 a[48:51], v4 offset:4096
    v_mfma_f32_16x16x32_bf16 v[36:39], a[0:3], a[36:39], v[36:39]
    ds_read_b128 a[52:55], v4 offset:8192
    v_mfma_f32_16x16x32_bf16 v[40:43], a[0:3], a[40:43], v[40:43]
    ds_read_b64_tr_b16 a[16:17], v5 offset:4096
    s_waitcnt lgkmcnt(8)
    v_mfma_f32_16x16x32_bf16 v[44:47], a[4:7], a[32:35], v[44:47]
    ds_read_b64_tr_b16 a[18:19], v5 offset:4608
    v_mfma_f32_16x16x32_bf16 v[48:51], a[4:7], a[36:39], v[48:51]
    ds_read_b64_tr_b16 a[20:21], v6 offset:4096
    ds_read_b64_tr_b16 a[22:23], v6 offset:4608
    v_mfma_f32_16x16x32_bf16 v[52:55], a[4:7], a[40:43], v[52:55]
    ds_read_b64_tr_b16 a[24:25], v7 offset:4096
    s_waitcnt lgkmcnt(10)
    v_mfma_f32_16x16x32_bf16 v[56:59], a[8:11], a[32:35], v[56:59]
    ds_read_b64_tr_b16 a[26:27], v7 offset:4608
    v_mfma_f32_16x16x32_bf16 v[60:63], a[8:11], a[36:39], v[60:63]
    ds_read_b64_tr_b16 a[28:29], v8 offset:4096
    v_mfma_f32_16x16x32_bf16 v[64:67], a[8:11], a[40:43], v[64:67]
    ds_read_b64_tr_b16 a[30:31], v8 offset:4608
    s_waitcnt lgkmcnt(11)
    v_mfma_f32_16x16x32_bf16 v[68:71], a[12:15], a[32:35], v[68:71]
    s_add_u32 s60, s58, 6
    s_and_b32 s60, s60, 15
    s_and_b32 s61, s60, 3
    s_lshl_b32 s61, s61, 6
    s_lshr_b32 s60, s60, 2
    s_mul_i32 s60, s60, 12288
    s_add_u32 s60, s60, 114688
    v_xor_b32 v3, s61, v2
    v_add_u32 v3, s60, v3
    v_mfma_f32_16x16x32_bf16 v[72:75], a[12:15], a[36:39], v[72:75]
    v_mfma_f32_16x16x32_bf16 v[76:79], a[12:15], a[40:43], v[76:79]
    v_and_b32_e64 v95, 3, v1
    v_lshl_add_u32 v94, v95, 3, v94
    v_xor_b32 v24, 0, v94
    v_xor_b32 v25, 64, v94
    v_xor_b32 v26, 128, v94
    v_xor_b32 v27, 192, v94
    s_lshl_b32 s62, s3, 5
    v_and_b32 v92, 31, v1
    v_add_u32 v92, s62, v92
    v_cmp_le_u32 vcc, 48, v92
    v_subrev_u32 v95, 48, v92
    v_mov_b32 v94, 0
    s_nop 0
    v_cndmask_b32 v92, v92, v95, vcc
    s_barrier
    s_waitcnt lgkmcnt(6)
    v_mfma_f32_16x16x32_bf16 v[32:35], a[16:19], a[44:47], v[32:35]
    ds_read_b128 a[32:35], v3 offset:0
    ds_read_b128 a[36:39], v3 offset:4096
    v_mfma_f32_16x16x32_bf16 v[36:39], a[16:19], a[48:51], v[36:39]
    ds_read_b128 a[40:43], v3 offset:8192
    v_mfma_f32_16x16x32_bf16 v[40:43], a[16:19], a[52:55], v[40:43]
    ds_read_b64_tr_b16 a[0:1], v5 offset:8192
    s_waitcnt lgkmcnt(8)
    v_mfma_f32_16x16x32_bf16 v[44:47], a[20:23], a[44:47], v[44:47]
    ds_read_b64_tr_b16 a[2:3], v5 offset:8704
    v_mfma_f32_16x16x32_bf16 v[48:51], a[20:23], a[48:51], v[48:51]
    ds_read_b64_tr_b16 a[4:5], v6 offset:8192
    ds_read_b64_tr_b16 a[6:7], v6 offset:8704
    v_mfma_f32_16x16x32_bf16 v[52:55], a[20:23], a[52:55], v[52:55]
    ds_read_b64_tr_b16 a[8:9], v7 offset:8192
    s_waitcnt lgkmcnt(10)
    v_mfma_f32_16x16x32_bf16 v[56:59], a[24:27], a[44:47], v[56:59]
    ds_read_b64_tr_b16 a[10:11], v7 offset:8704
    v_mfma_f32_16x16x32_bf16 v[60:63], a[24:27], a[48:51], v[60:63]
    ds_read_b64_tr_b16 a[12:13], v8 offset:8192
    v_mfma_f32_16x16x32_bf16 v[64:67], a[24:27], a[52:55], v[64:67]
    ds_read_b64_tr_b16 a[14:15], v8 offset:8704
    s_waitcnt lgkmcnt(11)
    v_mfma_f32_16x16x32_bf16 v[68:71], a[28:31], a[44:47], v[68:71]
    s_add_u32 s60, s58, 7
    s_and_b32 s60, s60, 15
    s_and_b32 s61, s60, 3
    s_lshl_b32 s61, s61, 6
    s_lshr_b32 s60, s60, 2
    s_mul_i32 s60, s60, 12288
    s_add_u32 s60, s60, 114688
    v_xor_b32 v4, s61, v2
    v_add_u32 v4, s60, v4
    v_mfma_f32_16x16x32_bf16 v[72:75], a[28:31], a[48:51], v[72:75]
    v_mfma_f32_16x16x32_bf16 v[76:79], a[28:31], a[52:55], v[76:79]
    v_mov_b32 v95, 256
    v_cndmask_b32 v94, v94, v95, vcc
    v_lshl_add_u32 v28, v92, 9, v94
    v_and_b32 v92, 15, v92
    v_lshl_add_u32 v28, v92, 4, v28
    v_lshl_add_u32 v28, v93, 3, v28
    v_add_u32 v28, 139264, v28
    v_lshrrev_b32 v92, 4, v1
    v_and_b32 v93, 15, v1
    v_xor_b32 v94, v92, v93
    v_lshlrev_b32 v94, 4, v94
    v_lshl_add_u32 v29, v93, 9, v94
    v_add_u32 v29, 139264, v29
    v_bfe_u32 v9, v1, 2, 2
    s_barrier
    s_waitcnt lgkmcnt(6)
    v_mfma_f32_16x16x32_bf16 v[32:35], a[0:3], a[32:35], v[32:35]
    ds_read_b128 a[44:47], v4 offset:0
    ds_read_b128 a[48:51], v4 offset:4096
    v_mfma_f32_16x16x32_bf16 v[36:39], a[0:3], a[36:39], v[36:39]
    ds_read_b128 a[52:55], v4 offset:8192
    v_mfma_f32_16x16x32_bf16 v[40:43], a[0:3], a[40:43], v[40:43]
    ds_read_b64_tr_b16 a[16:17], v5 offset:12288
    s_waitcnt lgkmcnt(8)
    v_mfma_f32_16x16x32_bf16 v[44:47], a[4:7], a[32:35], v[44:47]
    ds_read_b64_tr_b16 a[18:19], v5 offset:12800
    v_mfma_f32_16x16x32_bf16 v[48:51], a[4:7], a[36:39], v[48:51]
    ds_read_b64_tr_b16 a[20:21], v6 offset:12288
    ds_read_b64_tr_b16 a[22:23], v6 offset:12800
    v_mfma_f32_16x16x32_bf16 v[52:55], a[4:7], a[40:43], v[52:55]
    ds_read_b64_tr_b16 a[24:25], v7 offset:12288
    s_waitcnt lgkmcnt(10)
    v_mfma_f32_16x16x32_bf16 v[56:59], a[8:11], a[32:35], v[56:59]
    ds_read_b64_tr_b16 a[26:27], v7 offset:12800
    v_mfma_f32_16x16x32_bf16 v[60:63], a[8:11], a[36:39], v[60:63]
    ds_read_b64_tr_b16 a[28:29], v8 offset:12288
    v_mfma_f32_16x16x32_bf16 v[64:67], a[8:11], a[40:43], v[64:67]
    ds_read_b64_tr_b16 a[30:31], v8 offset:12800
    s_waitcnt lgkmcnt(11)
    v_mfma_f32_16x16x32_bf16 v[68:71], a[12:15], a[32:35], v[68:71]
    s_add_u32 s60, s58, 8
    s_and_b32 s60, s60, 15
    s_and_b32 s61, s60, 3
    s_lshl_b32 s61, s61, 6
    s_lshr_b32 s60, s60, 2
    s_mul_i32 s60, s60, 12288
    s_add_u32 s60, s60, 114688
    v_xor_b32 v3, s61, v2
    v_add_u32 v3, s60, v3
    v_mfma_f32_16x16x32_bf16 v[72:75], a[12:15], a[36:39], v[72:75]
    v_mfma_f32_16x16x32_bf16 v[76:79], a[12:15], a[40:43], v[76:79]
    v_and_b32 v15, 3, v1
    v_and_b32 v30, 2, v9
    v_and_b32_e64 v94, 1, v92
    v_lshl_or_b32 v30, v94, 2, v30
    v_lshrrev_b32 v94, 1, v15
    v_or_b32 v30, v30, v94
    v_lshlrev_b32 v30, 4, v30
    v_and_b32 v94, 1, v15
    v_lshl_add_u32 v30, v94, 3, v30
    v_lshl_add_u32 v94, v92, 3, v9
    v_lshl_add_u32 v30, v94, 7, v30
    v_lshlrev_b32_e64 v31, 4, v1
    s_mov_b32 s88, 49152
    s_cmp_eq_u32 s3, 1
    s_cselect_b32 s88, 57344, s88
    s_barrier
    s_waitcnt lgkmcnt(6)
    v_mfma_f32_16x16x32_bf16 v[32:35], a[16:19], a[44:47], v[32:35]
    ds_read_b128 a[32:35], v3 offset:0
    ds_read_b128 a[36:39], v3 offset:4096
    v_mfma_f32_16x16x32_bf16 v[36:39], a[16:19], a[48:51], v[36:39]
    ds_read_b128 a[40:43], v3 offset:8192
    v_mfma_f32_16x16x32_bf16 v[40:43], a[16:19], a[52:55], v[40:43]
    ds_read_b64_tr_b16 a[0:1], v5 offset:0
    s_waitcnt lgkmcnt(8)
    v_mfma_f32_16x16x32_bf16 v[44:47], a[20:23], a[44:47], v[44:47]
    ds_read_b64_tr_b16 a[2:3], v5 offset:512
    v_mfma_f32_16x16x32_bf16 v[48:51], a[20:23], a[48:51], v[48:51]
    ds_read_b64_tr_b16 a[4:5], v6 offset:0
    ds_read_b64_tr_b16 a[6:7], v6 offset:512
    v_mfma_f32_16x16x32_bf16 v[52:55], a[20:23], a[52:55], v[52:55]
    ds_read_b64_tr_b16 a[8:9], v7 offset:0
    s_waitcnt lgkmcnt(10)
    v_mfma_f32_16x16x32_bf16 v[56:59], a[24:27], a[44:47], v[56:59]
    ds_read_b64_tr_b16 a[10:11], v7 offset:512
    v_mfma_f32_16x16x32_bf16 v[60:63], a[24:27], a[48:51], v[60:63]
    ds_read_b64_tr_b16 a[12:13], v8 offset:0
    v_mfma_f32_16x16x32_bf16 v[64:67], a[24:27], a[52:55], v[64:67]
    ds_read_b64_tr_b16 a[14:15], v8 offset:512
    s_waitcnt lgkmcnt(11)
    v_mfma_f32_16x16x32_bf16 v[68:71], a[28:31], a[44:47], v[68:71]
    s_add_u32 s60, s58, 9
    s_and_b32 s60, s60, 15
    s_and_b32 s61, s60, 3
    s_lshl_b32 s61, s61, 6
    s_lshr_b32 s60, s60, 2
    s_mul_i32 s60, s60, 12288
    s_add_u32 s60, s60, 114688
    v_xor_b32 v4, s61, v2
    v_add_u32_e64 v4, s60, v4
    v_mfma_f32_16x16x32_bf16 v[72:75], a[28:31], a[48:51], v[72:75]
    v_mfma_f32_16x16x32_bf16 v[76:79], a[28:31], a[52:55], v[76:79]
    s_cmp_eq_u32 s3, 2
    s_cselect_b32 s88, 114688, s88
    s_cmp_eq_u32 s3, 3
    s_cselect_b32 s88, 122880, s88
    s_mov_b32 s89, 131072
    s_cmp_eq_u32 s3, 1
    s_cselect_b32 s89, 90112, s89
    s_cmp_eq_u32 s3, 2
    s_cselect_b32 s89, 81920, s89
    s_cmp_eq_u32 s3, 3
    s_cselect_b32 s89, 73728, s89
    s_mov_b32 s90, 16384
    s_barrier
    s_waitcnt lgkmcnt(6)
    v_mfma_f32_16x16x32_bf16 v[32:35], a[0:3], a[32:35], v[32:35]
    ds_read_b128 a[44:47], v4 offset:0
    ds_read_b128 a[48:51], v4 offset:4096
    v_mfma_f32_16x16x32_bf16 v[36:39], a[0:3], a[36:39], v[36:39]
    ds_read_b128 a[52:55], v4 offset:8192
    v_mfma_f32_16x16x32_bf16 v[40:43], a[0:3], a[40:43], v[40:43]
    ds_read_b64_tr_b16 a[16:17], v5 offset:4096
    s_waitcnt lgkmcnt(8)
    v_mfma_f32_16x16x32_bf16 v[44:47], a[4:7], a[32:35], v[44:47]
    ds_read_b64_tr_b16 a[18:19], v5 offset:4608
    v_mfma_f32_16x16x32_bf16 v[48:51], a[4:7], a[36:39], v[48:51]
    ds_read_b64_tr_b16 a[20:21], v6 offset:4096
    ds_read_b64_tr_b16 a[22:23], v6 offset:4608
    v_mfma_f32_16x16x32_bf16 v[52:55], a[4:7], a[40:43], v[52:55]
    ds_read_b64_tr_b16 a[24:25], v7 offset:4096
    s_waitcnt lgkmcnt(10)
    v_mfma_f32_16x16x32_bf16 v[56:59], a[8:11], a[32:35], v[56:59]
    ds_read_b64_tr_b16 a[26:27], v7 offset:4608
    v_mfma_f32_16x16x32_bf16 v[60:63], a[8:11], a[36:39], v[60:63]
    ds_read_b64_tr_b16 a[28:29], v8 offset:4096
    v_mfma_f32_16x16x32_bf16 v[64:67], a[8:11], a[40:43], v[64:67]
    ds_read_b64_tr_b16 a[30:31], v8 offset:4608
    s_waitcnt lgkmcnt(11)
    v_mfma_f32_16x16x32_bf16 v[68:71], a[12:15], a[32:35], v[68:71]
    s_add_u32 s60, s58, 10
    s_and_b32 s60, s60, 15
    s_and_b32 s61, s60, 3
    s_lshl_b32 s61, s61, 6
    s_lshr_b32 s60, s60, 2
    s_mul_i32 s60, s60, 12288
    s_add_u32 s60, s60, 114688
    v_xor_b32 v3, s61, v2
    v_add_u32_e64 v3, s60, v3
    v_mfma_f32_16x16x32_bf16 v[72:75], a[12:15], a[36:39], v[72:75]
    v_mfma_f32_16x16x32_bf16 v[76:79], a[12:15], a[40:43], v[76:79]
    s_cmp_eq_u32 s3, 1
    s_cselect_b32 s90, 65536, s90
    s_cmp_eq_u32 s3, 2
    s_cselect_b32 s90, 24576, s90
    s_cmp_eq_u32 s3, 3
    s_cselect_b32 s90, 106496, s90
    s_mov_b32 s91, 32768
    s_cmp_eq_u32 s3, 1
    s_cselect_b32 s91, 98304, s91
    s_cmp_eq_u32 s3, 2
    s_cselect_b32 s91, 40960, s91
    s_cmp_eq_u32 s3, 3
    s_cselect_b32 s91, 0, s91
    v_mov_b32 v10, 0
    s_barrier
    s_waitcnt lgkmcnt(6)
    v_mfma_f32_16x16x32_bf16 v[32:35], a[16:19], a[44:47], v[32:35]
    ds_read_b128 a[32:35], v3 offset:0
    ds_read_b128 a[36:39], v3 offset:4096
    v_mfma_f32_16x16x32_bf16 v[36:39], a[16:19], a[48:51], v[36:39]
    ds_read_b128 a[40:43], v3 offset:8192
    v_mfma_f32_16x16x32_bf16 v[40:43], a[16:19], a[52:55], v[40:43]
    ds_read_b64_tr_b16 a[0:1], v5 offset:8192
    s_waitcnt lgkmcnt(8)
    v_mfma_f32_16x16x32_bf16 v[44:47], a[20:23], a[44:47], v[44:47]
    ds_read_b64_tr_b16 a[2:3], v5 offset:8704
    v_mfma_f32_16x16x32_bf16 v[48:51], a[20:23], a[48:51], v[48:51]
    ds_read_b64_tr_b16 a[4:5], v6 offset:8192
    ds_read_b64_tr_b16 a[6:7], v6 offset:8704
    v_mfma_f32_16x16x32_bf16 v[52:55], a[20:23], a[52:55], v[52:55]
    ds_read_b64_tr_b16 a[8:9], v7 offset:8192
    s_waitcnt lgkmcnt(10)
    v_mfma_f32_16x16x32_bf16 v[56:59], a[24:27], a[44:47], v[56:59]
    ds_read_b64_tr_b16 a[10:11], v7 offset:8704
    v_mfma_f32_16x16x32_bf16 v[60:63], a[24:27], a[48:51], v[60:63]
    ds_read_b64_tr_b16 a[12:13], v8 offset:8192
    v_mfma_f32_16x16x32_bf16 v[64:67], a[24:27], a[52:55], v[64:67]
    ds_read_b64_tr_b16 a[14:15], v8 offset:8704
    s_waitcnt lgkmcnt(11)
    v_mfma_f32_16x16x32_bf16 v[68:71], a[28:31], a[44:47], v[68:71]
    s_add_u32 s60, s58, 11
    s_and_b32 s60, s60, 15
    s_and_b32 s61, s60, 3
    s_lshl_b32 s61, s61, 6
    s_lshr_b32 s60, s60, 2
    s_mul_i32 s60, s60, 12288
    s_add_u32 s60, s60, 114688
    v_xor_b32 v4, s61, v2
    v_add_u32 v4, s60, v4
    v_mfma_f32_16x16x32_bf16 v[72:75], a[28:31], a[48:51], v[72:75]
    v_mfma_f32_16x16x32_bf16 v[76:79], a[28:31], a[52:55], v[76:79]
    s_lshl_b32 s63, s92, 4
    s_add_u32 s63, s63, s93
    s_mul_i32 s63, s63, 49152
    s_add_u32 s24, s52, s63
    s_addc_u32 s25, s53, 0
    s_and_b32 s25, s25, 0xffff
    s_mov_b32 s26, 49152
    s_mov_b32 s27, 0x20000
    s_cmp_eq_u32 s57, 1
    s_cselect_b32 s34, s44, s34
    s_cselect_b32 s35, s45, s35
    s_lshl_b32 s62, s56, 3
    s_add_u32 s62, s62, s54
    s_lshl_b32 s62, s62, 18
    s_barrier
    s_waitcnt lgkmcnt(6)
    v_mfma_f32_16x16x32_bf16 v[32:35], a[0:3], a[32:35], v[32:35]
    ds_read_b128 a[44:47], v4 offset:0
    ds_read_b128 a[48:51], v4 offset:4096
    v_mfma_f32_16x16x32_bf16 v[36:39], a[0:3], a[36:39], v[36:39]
    ds_read_b128 a[52:55], v4 offset:8192
    v_mfma_f32_16x16x32_bf16 v[40:43], a[0:3], a[40:43], v[40:43]
    ds_read_b64_tr_b16 a[16:17], v5 offset:12288
    s_waitcnt lgkmcnt(8)
    v_mfma_f32_16x16x32_bf16 v[44:47], a[4:7], a[32:35], v[44:47]
    ds_read_b64_tr_b16 a[18:19], v5 offset:12800
    v_mfma_f32_16x16x32_bf16 v[48:51], a[4:7], a[36:39], v[48:51]
    ds_read_b64_tr_b16 a[20:21], v6 offset:12288
    ds_read_b64_tr_b16 a[22:23], v6 offset:12800
    v_mfma_f32_16x16x32_bf16 v[52:55], a[4:7], a[40:43], v[52:55]
    ds_read_b64_tr_b16 a[24:25], v7 offset:12288
    s_waitcnt lgkmcnt(10)
    v_mfma_f32_16x16x32_bf16 v[56:59], a[8:11], a[32:35], v[56:59]
    ds_read_b64_tr_b16 a[26:27], v7 offset:12800
    v_mfma_f32_16x16x32_bf16 v[60:63], a[8:11], a[36:39], v[60:63]
    ds_read_b64_tr_b16 a[28:29], v8 offset:12288
    v_mfma_f32_16x16x32_bf16 v[64:67], a[8:11], a[40:43], v[64:67]
    ds_read_b64_tr_b16 a[30:31], v8 offset:12800
    s_waitcnt lgkmcnt(11)
    v_mfma_f32_16x16x32_bf16 v[68:71], a[12:15], a[32:35], v[68:71]
    s_add_u32 s60, s58, 12
    s_and_b32 s60, s60, 15
    s_and_b32 s61, s60, 3
    s_lshl_b32 s61, s61, 6
    s_lshr_b32 s60, s60, 2
    s_mul_i32 s60, s60, 12288
    s_add_u32 s60, s60, 114688
    v_xor_b32 v3, s61, v2
    v_add_u32 v3, s60, v3
    v_mfma_f32_16x16x32_bf16 v[72:75], a[12:15], a[36:39], v[72:75]
    v_mfma_f32_16x16x32_bf16 v[76:79], a[12:15], a[40:43], v[76:79]
    s_add_u32 s12, s34, s62
    s_addc_u32 s13, s35, 0
    s_and_b32 s13, s13, 0xffff
    s_mov_b32 s14, 262144
    s_mov_b32 s15, 0x20000
    v_mov_b32 v96, 0
    v_mov_b32 v97, 0
    v_mov_b32 v98, 0
    v_mov_b32 v99, 0
    v_mov_b32 v100, 0
    v_mov_b32 v101, 0
    v_mov_b32 v102, 0
    v_mov_b32 v103, 0
    v_mov_b32_e64 v104, 0
    s_barrier
    s_waitcnt lgkmcnt(6)
    v_mfma_f32_16x16x32_bf16 v[32:35], a[16:19], a[44:47], v[32:35]
    ds_read_b128 a[32:35], v3 offset:0
    ds_read_b128 a[36:39], v3 offset:4096
    v_mfma_f32_16x16x32_bf16 v[36:39], a[16:19], a[48:51], v[36:39]
    ds_read_b128 a[40:43], v3 offset:8192
    v_mfma_f32_16x16x32_bf16 v[40:43], a[16:19], a[52:55], v[40:43]
    ds_read_b64_tr_b16 a[0:1], v5 offset:0
    s_waitcnt lgkmcnt(8)
    v_mfma_f32_16x16x32_bf16 v[44:47], a[20:23], a[44:47], v[44:47]
    ds_read_b64_tr_b16 a[2:3], v5 offset:512
    v_mfma_f32_16x16x32_bf16 v[48:51], a[20:23], a[48:51], v[48:51]
    ds_read_b64_tr_b16 a[4:5], v6 offset:0
    ds_read_b64_tr_b16 a[6:7], v6 offset:512
    v_mfma_f32_16x16x32_bf16 v[52:55], a[20:23], a[52:55], v[52:55]
    ds_read_b64_tr_b16 a[8:9], v7 offset:0
    s_waitcnt lgkmcnt(10)
    v_mfma_f32_16x16x32_bf16 v[56:59], a[24:27], a[44:47], v[56:59]
    ds_read_b64_tr_b16 a[10:11], v7 offset:512
    v_mfma_f32_16x16x32_bf16 v[60:63], a[24:27], a[48:51], v[60:63]
    ds_read_b64_tr_b16 a[12:13], v8 offset:0
    v_mfma_f32_16x16x32_bf16 v[64:67], a[24:27], a[52:55], v[64:67]
    ds_read_b64_tr_b16 a[14:15], v8 offset:512
    s_waitcnt lgkmcnt(11)
    v_mfma_f32_16x16x32_bf16 v[68:71], a[28:31], a[44:47], v[68:71]
    s_add_u32 s60, s58, 13
    s_and_b32 s60, s60, 15
    s_and_b32 s61, s60, 3
    s_lshl_b32 s61, s61, 6
    s_lshr_b32 s60, s60, 2
    s_mul_i32 s60, s60, 12288
    s_add_u32 s60, s60, 114688
    v_xor_b32 v4, s61, v2
    v_add_u32 v4, s60, v4
    v_mfma_f32_16x16x32_bf16 v[72:75], a[28:31], a[48:51], v[72:75]
    v_mfma_f32_16x16x32_bf16 v[76:79], a[28:31], a[52:55], v[76:79]
    v_mov_b32 v105, 0
    v_mov_b32 v106, 0
    v_mov_b32 v107, 0
    v_mov_b32 v108, 0
    v_mov_b32 v109, 0
    v_mov_b32 v110, 0
    v_mov_b32 v111, 0
    v_mov_b32 v112, 0
    v_mov_b32 v113, 0
    v_mov_b32 v114, 0
    v_mov_b32 v115, 0
    v_mov_b32 v116, 0
    v_mov_b32_e64 v117, 0
    s_barrier
    s_waitcnt lgkmcnt(6)
    v_mfma_f32_16x16x32_bf16 v[32:35], a[0:3], a[32:35], v[32:35]
    ds_read_b128 a[44:47], v4 offset:0
    ds_read_b128 a[48:51], v4 offset:4096
    v_mfma_f32_16x16x32_bf16 v[36:39], a[0:3], a[36:39], v[36:39]
    ds_read_b128 a[52:55], v4 offset:8192
    v_mfma_f32_16x16x32_bf16 v[40:43], a[0:3], a[40:43], v[40:43]
    ds_read_b64_tr_b16 a[16:17], v5 offset:4096
    s_waitcnt lgkmcnt(8)
    v_mfma_f32_16x16x32_bf16 v[44:47], a[4:7], a[32:35], v[44:47]
    ds_read_b64_tr_b16 a[18:19], v5 offset:4608
    v_mfma_f32_16x16x32_bf16 v[48:51], a[4:7], a[36:39], v[48:51]
    ds_read_b64_tr_b16 a[20:21], v6 offset:4096
    ds_read_b64_tr_b16 a[22:23], v6 offset:4608
    v_mfma_f32_16x16x32_bf16 v[52:55], a[4:7], a[40:43], v[52:55]
    ds_read_b64_tr_b16 a[24:25], v7 offset:4096
    s_waitcnt lgkmcnt(10)
    v_mfma_f32_16x16x32_bf16 v[56:59], a[8:11], a[32:35], v[56:59]
    ds_read_b64_tr_b16 a[26:27], v7 offset:4608
    v_mfma_f32_16x16x32_bf16 v[60:63], a[8:11], a[36:39], v[60:63]
    ds_read_b64_tr_b16 a[28:29], v8 offset:4096
    v_mfma_f32_16x16x32_bf16 v[64:67], a[8:11], a[40:43], v[64:67]
    ds_read_b64_tr_b16 a[30:31], v8 offset:4608
    s_waitcnt lgkmcnt(11)
    v_mfma_f32_16x16x32_bf16 v[68:71], a[12:15], a[32:35], v[68:71]
    s_add_u32 s60, s58, 14
    s_and_b32 s60, s60, 15
    s_and_b32 s61, s60, 3
    s_lshl_b32 s61, s61, 6
    s_lshr_b32 s60, s60, 2
    s_mul_i32 s60, s60, 12288
    s_add_u32 s60, s60, 114688
    v_xor_b32 v3, s61, v2
    v_add_u32 v3, s60, v3
    v_mfma_f32_16x16x32_bf16 v[72:75], a[12:15], a[36:39], v[72:75]
    v_mfma_f32_16x16x32_bf16 v[76:79], a[12:15], a[40:43], v[76:79]
    v_mov_b32 v118, 0
    v_mov_b32 v119, 0
    v_mov_b32 v120, 0
    v_mov_b32 v121, 0
    v_mov_b32 v122, 0
    v_mov_b32 v123, 0
    v_mov_b32 v124, 0
    v_mov_b32 v125, 0
    v_mov_b32 v126, 0
    v_mov_b32 v127, 0
    v_mov_b32 v128, 0
    v_mov_b32 v129, 0
    v_mov_b32 v130, 0
    v_mov_b32 v131, 0
    s_barrier
    s_waitcnt lgkmcnt(6)
    v_mfma_f32_16x16x32_bf16 v[32:35], a[16:19], a[44:47], v[32:35]
    ds_read_b128 a[32:35], v3 offset:0
    ds_read_b128 a[36:39], v3 offset:4096
    v_mfma_f32_16x16x32_bf16 v[36:39], a[16:19], a[48:51], v[36:39]
    ds_read_b128 a[40:43], v3 offset:8192
    v_mfma_f32_16x16x32_bf16 v[40:43], a[16:19], a[52:55], v[40:43]
    ds_read_b64_tr_b16 a[0:1], v5 offset:8192
    s_waitcnt lgkmcnt(8)
    v_mfma_f32_16x16x32_bf16 v[44:47], a[20:23], a[44:47], v[44:47]
    ds_read_b64_tr_b16 a[2:3], v5 offset:8704
    v_mfma_f32_16x16x32_bf16 v[48:51], a[20:23], a[48:51], v[48:51]
    ds_read_b64_tr_b16 a[4:5], v6 offset:8192
    ds_read_b64_tr_b16 a[6:7], v6 offset:8704
    v_mfma_f32_16x16x32_bf16 v[52:55], a[20:23], a[52:55], v[52:55]
    ds_read_b64_tr_b16 a[8:9], v7 offset:8192
    s_waitcnt lgkmcnt(10)
    v_mfma_f32_16x16x32_bf16 v[56:59], a[24:27], a[44:47], v[56:59]
    ds_read_b64_tr_b16 a[10:11], v7 offset:8704
    v_mfma_f32_16x16x32_bf16 v[60:63], a[24:27], a[48:51], v[60:63]
    ds_read_b64_tr_b16 a[12:13], v8 offset:8192
    v_mfma_f32_16x16x32_bf16 v[64:67], a[24:27], a[52:55], v[64:67]
    ds_read_b64_tr_b16 a[14:15], v8 offset:8704
    s_waitcnt lgkmcnt(11)
    v_mfma_f32_16x16x32_bf16 v[68:71], a[28:31], a[44:47], v[68:71]
    s_add_u32 s60, s58, 15
    s_and_b32 s60, s60, 15
    s_and_b32 s61, s60, 3
    s_lshl_b32 s61, s61, 6
    s_lshr_b32 s60, s60, 2
    s_mul_i32 s60, s60, 12288
    s_add_u32 s60, s60, 114688
    v_xor_b32 v4, s61, v2
    v_add_u32 v4, s60, v4
    v_mfma_f32_16x16x32_bf16 v[72:75], a[28:31], a[48:51], v[72:75]
    v_mfma_f32_16x16x32_bf16 v[76:79], a[28:31], a[52:55], v[76:79]
    v_mov_b32 v132, 0
    v_mov_b32 v133, 0
    v_mov_b32 v134, 0
    v_mov_b32 v135, 0
    v_mov_b32 v136, 0
    v_mov_b32 v137, 0
    v_mov_b32 v138, 0
    v_mov_b32 v139, 0
    v_mov_b32 v140, 0
    v_mov_b32 v141, 0
    v_mov_b32 v142, 0
    v_mov_b32 v143, 0
    v_mov_b32 v144, 0
    v_mov_b32 v145, 0
    s_barrier
    s_waitcnt lgkmcnt(6)
    v_mfma_f32_16x16x32_bf16 v[32:35], a[0:3], a[32:35], v[32:35]
    ds_read_b128 a[44:47], v4 offset:0
    ds_read_b128 a[48:51], v4 offset:4096
    v_mfma_f32_16x16x32_bf16 v[36:39], a[0:3], a[36:39], v[36:39]
    ds_read_b128 a[52:55], v4 offset:8192
    v_mfma_f32_16x16x32_bf16 v[40:43], a[0:3], a[40:43], v[40:43]
    ds_read_b64_tr_b16 a[16:17], v5 offset:12288
    s_waitcnt lgkmcnt(8)
    v_mfma_f32_16x16x32_bf16 v[44:47], a[4:7], a[32:35], v[44:47]
    ds_read_b64_tr_b16 a[18:19], v5 offset:12800
    v_mfma_f32_16x16x32_bf16 v[48:51], a[4:7], a[36:39], v[48:51]
    ds_read_b64_tr_b16 a[20:21], v6 offset:12288
    ds_read_b64_tr_b16 a[22:23], v6 offset:12800
    v_mfma_f32_16x16x32_bf16 v[52:55], a[4:7], a[40:43], v[52:55]
    ds_read_b64_tr_b16 a[24:25], v7 offset:12288
    s_waitcnt lgkmcnt(10)
    v_mfma_f32_16x16x32_bf16 v[56:59], a[8:11], a[32:35], v[56:59]
    ds_read_b64_tr_b16 a[26:27], v7 offset:12800
    v_mfma_f32_16x16x32_bf16 v[60:63], a[8:11], a[36:39], v[60:63]
    ds_read_b64_tr_b16 a[28:29], v8 offset:12288
    v_mfma_f32_16x16x32_bf16 v[64:67], a[8:11], a[40:43], v[64:67]
    ds_read_b64_tr_b16 a[30:31], v8 offset:12800
    s_waitcnt lgkmcnt(11)
    v_mfma_f32_16x16x32_bf16 v[68:71], a[12:15], a[32:35], v[68:71]
    v_mfma_f32_16x16x32_bf16 v[72:75], a[12:15], a[36:39], v[72:75]
    v_mfma_f32_16x16x32_bf16 v[76:79], a[12:15], a[40:43], v[76:79]
    v_mov_b32 v146, 0
    v_mov_b32 v147, 0
    v_mov_b32 v148, 0
    v_mov_b32 v149, 0
    v_mov_b32 v150, 0
    v_mov_b32 v151, 0
    v_mov_b32 v152, 0
    v_mov_b32 v153, 0
    v_mov_b32 v154, 0
    v_mov_b32 v155, 0
    v_mov_b32 v156, 0
    v_mov_b32 v157, 0
    v_mov_b32 v158, 0
    v_mov_b32_e64 v159, 0
    s_barrier
    s_waitcnt lgkmcnt(6)
    v_mfma_f32_16x16x32_bf16 v[32:35], a[16:19], a[44:47], v[32:35]
    v_mfma_f32_16x16x32_bf16 v[36:39], a[16:19], a[48:51], v[36:39]
    v_mfma_f32_16x16x32_bf16 v[40:43], a[16:19], a[52:55], v[40:43]
    s_waitcnt lgkmcnt(4)
    v_mfma_f32_16x16x32_bf16 v[44:47], a[20:23], a[44:47], v[44:47]
    v_mfma_f32_16x16x32_bf16 v[48:51], a[20:23], a[48:51], v[48:51]
    v_mfma_f32_16x16x32_bf16 v[52:55], a[20:23], a[52:55], v[52:55]
    s_waitcnt lgkmcnt(2)
    v_mfma_f32_16x16x32_bf16 v[56:59], a[24:27], a[44:47], v[56:59]
    v_mfma_f32_16x16x32_bf16 v[60:63], a[24:27], a[48:51], v[60:63]
    v_mfma_f32_16x16x32_bf16 v[64:67], a[24:27], a[52:55], v[64:67]
    s_waitcnt lgkmcnt(0)
    v_mfma_f32_16x16x32_bf16 v[68:71], a[28:31], a[44:47], v[68:71]
    v_mfma_f32_16x16x32_bf16 v[72:75], a[28:31], a[48:51], v[72:75]
    v_mfma_f32_16x16x32_bf16 v[76:79], a[28:31], a[52:55], v[76:79]
    s_barrier
    v_pk_mul_f32 v[32:33], v[32:33], s[68:69]
    v_pk_mul_f32 v[34:35], v[34:35], s[68:69]
    v_cvt_pk_bf16_f32 v32, v32, v33
    v_cvt_pk_bf16_f32 v33, v34, v35
    ds_write_b64 v88, v[32:33] offset:0
    v_pk_mul_f32 v[36:37], v[36:37], s[68:69]
    v_pk_mul_f32 v[38:39], v[38:39], s[68:69]
    v_cvt_pk_bf16_f32 v36, v36, v37
    v_cvt_pk_bf16_f32 v37, v38, v39
    ds_write_b64 v88, v[36:37] offset:4096
    v_pk_mul_f32 v[40:41], v[40:41], s[68:69]
    v_pk_mul_f32 v[42:43], v[42:43], s[68:69]
    v_cvt_pk_bf16_f32 v40, v40, v41
    v_cvt_pk_bf16_f32 v41, v42, v43
    ds_write_b64 v88, v[40:41] offset:8192
    v_pk_mul_f32 v[44:45], v[44:45], s[68:69]
    v_pk_mul_f32 v[46:47], v[46:47], s[68:69]
    v_cvt_pk_bf16_f32 v44, v44, v45
    v_cvt_pk_bf16_f32 v45, v46, v47
    ds_write_b64 v89, v[44:45] offset:0
    v_pk_mul_f32 v[48:49], v[48:49], s[68:69]
    v_pk_mul_f32 v[50:51], v[50:51], s[68:69]
    v_cvt_pk_bf16_f32 v48, v48, v49
    v_cvt_pk_bf16_f32 v49, v50, v51
    ds_write_b64 v89, v[48:49] offset:4096
    v_pk_mul_f32 v[52:53], v[52:53], s[68:69]
    v_pk_mul_f32 v[54:55], v[54:55], s[68:69]
    v_cvt_pk_bf16_f32 v52, v52, v53
    v_cvt_pk_bf16_f32 v53, v54, v55
    ds_write_b64 v89, v[52:53] offset:8192
    v_pk_mul_f32 v[56:57], v[56:57], s[68:69]
    v_pk_mul_f32 v[58:59], v[58:59], s[68:69]
    v_cvt_pk_bf16_f32 v56, v56, v57
    v_cvt_pk_bf16_f32 v57, v58, v59
    ds_write_b64 v90, v[56:57] offset:0
    v_pk_mul_f32 v[60:61], v[60:61], s[68:69]
    v_pk_mul_f32 v[62:63], v[62:63], s[68:69]
    v_cvt_pk_bf16_f32 v60, v60, v61
    v_cvt_pk_bf16_f32 v61, v62, v63
    ds_write_b64 v90, v[60:61] offset:4096
    v_pk_mul_f32 v[64:65], v[64:65], s[68:69]
    v_pk_mul_f32 v[66:67], v[66:67], s[68:69]
    v_cvt_pk_bf16_f32 v64, v64, v65
    v_cvt_pk_bf16_f32 v65, v66, v67
    ds_write_b64 v90, v[64:65] offset:8192
    v_pk_mul_f32 v[68:69], v[68:69], s[68:69]
    v_pk_mul_f32 v[70:71], v[70:71], s[68:69]
    v_cvt_pk_bf16_f32 v68, v68, v69
    v_cvt_pk_bf16_f32 v69, v70, v71
    ds_write_b64 v91, v[68:69] offset:0
    v_pk_mul_f32 v[72:73], v[72:73], s[68:69]
    v_pk_mul_f32 v[74:75], v[74:75], s[68:69]
    v_cvt_pk_bf16_f32 v72, v72, v73
    v_cvt_pk_bf16_f32 v73, v74, v75
    ds_write_b64 v91, v[72:73] offset:4096
    v_pk_mul_f32 v[76:77], v[76:77], s[68:69]
    v_pk_mul_f32 v[78:79], v[78:79], s[68:69]
    v_cvt_pk_bf16_f32 v76, v76, v77
    v_cvt_pk_bf16_f32 v77, v78, v79
    ds_write_b64 v91, v[76:77] offset:8192
    s_cmp_eq_u32 s3, 3
    s_cbranch_scc1 L_wave3
    s_waitcnt lgkmcnt(0)
    s_barrier
    ds_read_b128 a[0:3], v80
    ds_read_b128 a[4:7], v81
    ds_read_b128 a[8:11], v82
    ds_read_b128 a[12:15], v83
    ds_read_b128 a[16:19], v84
    ds_read_b128 a[20:23], v85
    ds_read_b128 a[24:27], v86
    ds_read_b128 a[28:31], v87
    ds_read_b128 a[32:35], v16 offset:40960
    ds_read_b128 a[36:39], v17 offset:40960
    ds_read_b128 a[40:43], v18 offset:40960
    ds_read_b128 a[44:47], v19 offset:40960
    ds_read_b128 a[48:51], v20 offset:40960
    ds_read_b128 a[52:55], v21 offset:40960
    ds_read_b128 a[56:59], v22 offset:40960
    ds_read_b128 a[60:63], v23 offset:40960
    v_mov_b32 v80, 0
    v_mov_b32 v81, 0
    v_mov_b32 v82, 0
    v_mov_b32 v83, 0
    v_mov_b32 v84, 0
    v_mov_b32 v85, 0
    v_mov_b32 v86, 0
    v_mov_b32 v87, 0
    v_mov_b32 v88, 0
    v_mov_b32 v89, 0
    v_mov_b32 v90, 0
    v_mov_b32 v91, 0
    v_mov_b32 v92, 0
    v_mov_b32 v93, 0
    v_mov_b32 v94, 0
    v_mov_b32_e64 v95, 0
    s_waitcnt lgkmcnt(0)
    v_mfma_f32_32x32x16_bf16 v[32:47], a[32:35], a[0:3], 0
    ds_read_b128 a[32:35], v16 offset:32768
    v_mfma_f32_32x32x16_bf16 v[32:47], a[36:39], a[4:7], v[32:47]
    ds_read_b128 a[36:39], v17 offset:32768
    v_mfma_f32_32x32x16_bf16 v[32:47], a[40:43], a[8:11], v[32:47]
    ds_read_b128 a[40:43], v18 offset:32768
    v_mfma_f32_32x32x16_bf16 v[32:47], a[44:47], a[12:15], v[32:47]
    ds_read_b128 a[44:47], v19 offset:32768
    v_mfma_f32_32x32x16_bf16 v[32:47], a[48:51], a[16:19], v[32:47]
    ds_read_b128 a[48:51], v20 offset:32768
    v_mfma_f32_32x32x16_bf16 v[32:47], a[52:55], a[20:23], v[32:47]
    ds_read_b128 a[52:55], v21 offset:32768
    v_mfma_f32_32x32x16_bf16 v[32:47], a[56:59], a[24:27], v[32:47]
    ds_read_b128 a[56:59], v22 offset:32768
    v_mfma_f32_32x32x16_bf16 v[32:47], a[60:63], a[28:31], v[32:47]
    ds_read_b128 a[60:63], v23 offset:32768
    s_nop 7
    s_waitcnt lgkmcnt(0)
    v_mfma_f32_32x32x16_bf16 v[48:63], a[32:35], a[0:3], v[80:95]
    s_barrier
    ds_read_b128 a[32:35], v16 offset:24576
    ds_read_b64_tr_b16 a[64:65], v24 offset:0
    ds_read_b64_tr_b16 a[66:67], v24 offset:2048
    v_exp_f32 v2, v32
    v_mfma_f32_32x32x16_bf16 v[48:63], a[36:39], a[4:7], v[48:63]
    ds_read_b128 a[36:39], v17 offset:24576
    ds_read_b64_tr_b16 a[68:69], v25 offset:0
    ds_read_b64_tr_b16 a[70:71], v25 offset:2048
    v_exp_f32_e64 v3, v33
    v_mfma_f32_32x32x16_bf16 v[48:63], a[40:43], a[8:11], v[48:63]
    ds_read_b128 a[40:43], v18 offset:24576
    ds_read_b64_tr_b16 a[72:73], v26 offset:0
    ds_read_b64_tr_b16 a[74:75], v26 offset:2048
    v_add_f32_e64 v11, v2, v3
    v_cvt_pk_bf16_f32 v64, v2, v3
    v_mfma_f32_32x32x16_bf16 v[48:63], a[44:47], a[12:15], v[48:63]
    ds_read_b128 a[44:47], v19 offset:24576
    ds_read_b64_tr_b16 a[76:77], v27 offset:0
    ds_read_b64_tr_b16 a[78:79], v27 offset:2048
    v_exp_f32_e64 v4, v34
    v_mfma_f32_32x32x16_bf16 v[48:63], a[48:51], a[16:19], v[48:63]
    ds_read_b128 a[48:51], v20 offset:24576
    ds_read_b64_tr_b16 a[80:81], v24 offset:4096
    ds_read_b64_tr_b16 a[82:83], v24 offset:6144
    v_add_f32 v11, v11, v4
    v_exp_f32 v5, v35
    v_mfma_f32_32x32x16_bf16 v[48:63], a[52:55], a[20:23], v[48:63]
    ds_read_b128 a[52:55], v21 offset:24576
    ds_read_b64_tr_b16 a[84:85], v25 offset:4096
    ds_read_b64_tr_b16 a[86:87], v25 offset:6144
    v_add_f32_e64 v11, v11, v5
    v_cvt_pk_bf16_f32 v65, v4, v5
    v_mfma_f32_32x32x16_bf16 v[48:63], a[56:59], a[24:27], v[48:63]
    ds_read_b128 a[56:59], v22 offset:24576
    ds_read_b64_tr_b16 a[88:89], v26 offset:4096
    ds_read_b64_tr_b16 a[90:91], v26 offset:6144
    v_exp_f32_e64 v6, v36
    v_mfma_f32_32x32x16_bf16 v[48:63], a[60:63], a[28:31], v[48:63]
    ds_read_b128 a[60:63], v23 offset:24576
    ds_read_b64_tr_b16 a[92:93], v27 offset:4096
    ds_read_b64_tr_b16 a[94:95], v27 offset:6144
    v_add_f32 v11, v11, v6
    s_nop 0
    v_exp_f32 v7, v37
    v_exp_f32 v8, v38
    v_exp_f32 v9, v39
    s_nop 0
    v_add_f32 v11, v11, v7
    v_add_f32 v11, v11, v8
    v_add_f32_e64 v11, v11, v9
    v_cvt_pk_bf16_f32 v66, v6, v7
    v_cvt_pk_bf16_f32 v67, v8, v9
    s_nop 0
    v_exp_f32 v2, v40
    v_exp_f32 v3, v41
    v_exp_f32 v4, v42
    s_nop 0
    v_add_f32 v11, v11, v2
    v_add_f32 v11, v11, v3
    v_add_f32 v11, v11, v4
    v_cvt_pk_bf16_f32 v68, v2, v3
    v_exp_f32 v5, v43
    s_nop 0
    v_add_f32_e64 v11, v11, v5
    v_cvt_pk_bf16_f32 v69, v4, v5
    v_exp_f32 v6, v44
    v_exp_f32 v7, v45
    s_nop 0
    v_add_f32 v11, v11, v6
    v_add_f32_e64 v11, v11, v7
    v_cvt_pk_bf16_f32 v70, v6, v7
    v_exp_f32 v8, v46
    s_nop 0
    v_add_f32 v11, v11, v8
    v_exp_f32 v9, v47
    s_nop 0
    v_cmp_lt_f32 vcc, s67, v11
    v_cmp_gt_f32 s[70:71], s30, v11
    v_add_f32_e64 v11, v11, v9
    v_cvt_pk_bf16_f32 v71, v8, v9
    s_or_b64 vcc, vcc, s[70:71]
    s_cbranch_vccnz L_rare_0
L_back_0:
    v_add_f32_e64 v10, v10, v11
    s_waitcnt lgkmcnt(0)
    s_mov_b32 s64, 5
L_p2_loop:
    v_mfma_f32_32x32x16_bf16 v[32:47], a[32:35], a[0:3], v[80:95]
    s_barrier
    ds_read_b128 a[32:35], v16 offset:16384
    v_exp_f32 v2, v48
    v_exp_f32_e64 v3, v49
    v_mfma_f32_32x32x16_bf16 v[32:47], a[36:39], a[4:7], v[32:47]
    ds_read_b128 a[36:39], v17 offset:16384
    v_add_f32_e64 v11, v2, v3
    v_cvt_pk_bf16_f32 v72, v2, v3
    v_exp_f32_e64 v4, v50
    v_mfma_f32_32x32x16_bf16 v[32:47], a[40:43], a[8:11], v[32:47]
    ds_read_b128 a[40:43], v18 offset:16384
    v_add_f32 v11, v11, v4
    v_exp_f32 v5, v51
    v_exp_f32_e64 v6, v52
    v_mfma_f32_32x32x16_bf16 v[32:47], a[44:47], a[12:15], v[32:47]
    ds_read_b128 a[44:47], v19 offset:16384
    v_add_f32 v11, v11, v5
    v_add_f32 v11, v11, v6
    v_cvt_pk_bf16_f32 v73, v4, v5
    v_exp_f32_e64 v7, v53
    v_mfma_f32_32x32x16_bf16 v[32:47], a[48:51], a[16:19], v[32:47]
    ds_read_b128 a[48:51], v20 offset:16384
    v_add_f32_e64 v11, v11, v7
    v_cvt_pk_bf16_f32 v74, v6, v7
    v_exp_f32_e64 v8, v54
    v_mfma_f32_32x32x16_bf16 v[32:47], a[52:55], a[20:23], v[32:47]
    ds_read_b128 a[52:55], v21 offset:16384
    v_add_f32 v11, v11, v8
    v_exp_f32 v9, v55
    v_exp_f32_e64 v2, v56
    v_mfma_f32_32x32x16_bf16 v[32:47], a[56:59], a[24:27], v[32:47]
    ds_read_b128 a[56:59], v22 offset:16384
    v_add_f32 v11, v11, v9
    v_add_f32 v11, v11, v2
    v_cvt_pk_bf16_f32 v75, v8, v9
    v_exp_f32_e64 v3, v57
    v_mfma_f32_32x32x16_bf16 v[32:47], a[60:63], a[28:31], v[32:47]
    ds_read_b128 a[60:63], v23 offset:16384
    v_add_f32_e64 v11, v11, v3
    v_cvt_pk_bf16_f32 v76, v2, v3
    v_exp_f32 v4, v58
    s_waitcnt lgkmcnt(8)
    v_mfma_f32_32x32x16_bf16 v[96:111], a[64:67], v[64:67], v[96:111]
    ds_read_b64_tr_b16 a[64:65], v24 offset:8192
    ds_read_b64_tr_b16 a[66:67], v24 offset:10240
    v_add_f32 v11, v11, v4
    v_exp_f32 v5, v59
    v_mfma_f32_32x32x16_bf16 v[112:127], a[68:71], v[64:67], v[112:127]
    ds_read_b64_tr_b16 a[68:69], v25 offset:8192
    ds_read_b64_tr_b16 a[70:71], v25 offset:10240
    v_add_f32_e64 v11, v11, v5
    v_cvt_pk_bf16_f32 v77, v4, v5
    v_exp_f32_e64 v6, v60
    v_mfma_f32_32x32x16_bf16 v[128:143], a[72:75], v[64:67], v[128:143]
    ds_read_b64_tr_b16 a[72:73], v26 offset:8192
    ds_read_b64_tr_b16 a[74:75], v26 offset:10240
    v_add_f32 v11, v11, v6
    v_exp_f32 v7, v61
    v_mfma_f32_32x32x16_bf16 v[144:159], a[76:79], v[64:67], v[144:159]
    ds_read_b64_tr_b16 a[76:77], v27 offset:8192
    ds_read_b64_tr_b16 a[78:79], v27 offset:10240
    v_add_f32_e64 v11, v11, v7
    v_cvt_pk_bf16_f32 v78, v6, v7
    v_exp_f32_e64 v8, v62
    v_mfma_f32_32x32x16_bf16 v[96:111], a[80:83], v[68:71], v[96:111]
    ds_read_b64_tr_b16 a[80:81], v24 offset:12288
    ds_read_b64_tr_b16 a[82:83], v24 offset:14336
    v_add_f32 v11, v11, v8
    v_exp_f32 v9, v63
    v_mfma_f32_32x32x16_bf16 v[112:127], a[84:87], v[68:71], v[112:127]
    ds_read_b64_tr_b16 a[84:85], v25 offset:12288
    ds_read_b64_tr_b16 a[86:87], v25 offset:14336
    v_add_f32_e64 v11, v11, v9
    v_cvt_pk_bf16_f32 v79, v8, v9
    v_mfma_f32_32x32x16_bf16 v[128:143], a[88:91], v[68:71], v[128:143]
    v_cmp_lt_f32 vcc, s67, v11
    ds_read_b64_tr_b16 a[88:89], v26 offset:12288
    ds_read_b64_tr_b16 a[90:91], v26 offset:14336
    v_mfma_f32_32x32x16_bf16 v[144:159], a[92:95], v[68:71], v[144:159]
    ds_read_b64_tr_b16 a[92:93], v27 offset:12288
    ds_read_b64_tr_b16 a[94:95], v27 offset:14336
    s_cbranch_vccnz L_rare_1
L_back_1:
    v_add_f32 v10, v10, v11
    s_waitcnt lgkmcnt(15)
    v_mfma_f32_32x32x16_bf16 v[48:63], a[32:35], a[0:3], v[80:95]
    s_barrier
    ds_read_b128 a[32:35], v16 offset:8192
    v_exp_f32 v2, v32
    v_exp_f32_e64 v3, v33
    v_mfma_f32_32x32x16_bf16 v[48:63], a[36:39], a[4:7], v[48:63]
    ds_read_b128 a[36:39], v17 offset:8192
    v_add_f32_e64 v11, v2, v3
    v_cvt_pk_bf16_f32 v64, v2, v3
    v_exp_f32_e64 v4, v34
    v_mfma_f32_32x32x16_bf16 v[48:63], a[40:43], a[8:11], v[48:63]
    ds_read_b128 a[40:43], v18 offset:8192
    v_add_f32 v11, v11, v4
    v_exp_f32 v5, v35
    v_exp_f32_e64 v6, v36
    v_mfma_f32_32x32x16_bf16 v[48:63], a[44:47], a[12:15], v[48:63]
    ds_read_b128 a[44:47], v19 offset:8192
    v_add_f32 v11, v11, v5
    v_add_f32 v11, v11, v6
    v_cvt_pk_bf16_f32 v65, v4, v5
    v_exp_f32_e64 v7, v37
    v_mfma_f32_32x32x16_bf16 v[48:63], a[48:51], a[16:19], v[48:63]
    ds_read_b128 a[48:51], v20 offset:8192
    v_add_f32_e64 v11, v11, v7
    v_cvt_pk_bf16_f32 v66, v6, v7
    v_exp_f32_e64 v8, v38
    v_mfma_f32_32x32x16_bf16 v[48:63], a[52:55], a[20:23], v[48:63]
    ds_read_b128 a[52:55], v21 offset:8192
    v_add_f32 v11, v11, v8
    v_exp_f32 v9, v39
    v_exp_f32_e64 v2, v40
    v_mfma_f32_32x32x16_bf16 v[48:63], a[56:59], a[24:27], v[48:63]
    ds_read_b128 a[56:59], v22 offset:8192
    v_add_f32 v11, v11, v9
    v_add_f32 v11, v11, v2
    v_cvt_pk_bf16_f32 v67, v8, v9
    v_exp_f32_e64 v3, v41
    v_mfma_f32_32x32x16_bf16 v[48:63], a[60:63], a[28:31], v[48:63]
    ds_read_b128 a[60:63], v23 offset:8192
    v_add_f32_e64 v11, v11, v3
    v_cvt_pk_bf16_f32 v68, v2, v3
    v_exp_f32 v4, v42
    s_waitcnt lgkmcnt(8)
    v_mfma_f32_32x32x16_bf16 v[96:111], a[64:67], v[72:75], v[96:111]
    ds_read_b64_tr_b16 a[64:65], v24 offset:16384
    ds_read_b64_tr_b16 a[66:67], v24 offset:18432
    v_add_f32 v11, v11, v4
    v_exp_f32 v5, v43
    v_mfma_f32_32x32x16_bf16 v[112:127], a[68:71], v[72:75], v[112:127]
    ds_read_b64_tr_b16 a[68:69], v25 offset:16384
    ds_read_b64_tr_b16 a[70:71], v25 offset:18432
    v_add_f32_e64 v11, v11, v5
    v_cvt_pk_bf16_f32 v69, v4, v5
    v_exp_f32_e64 v6, v44
    v_mfma_f32_32x32x16_bf16 v[128:143], a[72:75], v[72:75], v[128:143]
    ds_read_b64_tr_b16 a[72:73], v26 offset:16384
    ds_read_b64_tr_b16 a[74:75], v26 offset:18432
    v_add_f32 v11, v11, v6
    v_exp_f32 v7, v45
    v_mfma_f32_32x32x16_bf16 v[144:159], a[76:79], v[72:75], v[144:159]
    ds_read_b64_tr_b16 a[76:77], v27 offset:16384
    ds_read_b64_tr_b16 a[78:79], v27 offset:18432
    v_add_f32_e64 v11, v11, v7
    v_cvt_pk_bf16_f32 v70, v6, v7
    v_exp_f32_e64 v8, v46
    v_mfma_f32_32x32x16_bf16 v[96:111], a[80:83], v[76:79], v[96:111]
    ds_read_b64_tr_b16 a[80:81], v24 offset:20480
    ds_read_b64_tr_b16 a[82:83], v24 offset:22528
    v_add_f32 v11, v11, v8
    v_exp_f32 v9, v47
    v_mfma_f32_32x32x16_bf16 v[112:127], a[84:87], v[76:79], v[112:127]
    ds_read_b64_tr_b16 a[84:85], v25 offset:20480
    ds_read_b64_tr_b16 a[86:87], v25 offset:22528
    v_add_f32_e64 v11, v11, v9
    v_cvt_pk_bf16_f32 v71, v8, v9
    v_mfma_f32_32x32x16_bf16 v[128:143], a[88:91], v[76:79], v[128:143]
    v_cmp_lt_f32 vcc, s67, v11
    ds_read_b64_tr_b16 a[88:89], v26 offset:20480
    ds_read_b64_tr_b16 a[90:91], v26 offset:22528
    v_mfma_f32_32x32x16_bf16 v[144:159], a[92:95], v[76:79], v[144:159]
    ds_read_b64_tr_b16 a[92:93], v27 offset:20480
    ds_read_b64_tr_b16 a[94:95], v27 offset:22528
    s_cbranch_vccnz L_rare_2
L_back_2:
    v_add_f32 v10, v10, v11
    s_waitcnt lgkmcnt(15)
    v_mfma_f32_32x32x16_bf16 v[32:47], a[32:35], a[0:3], v[80:95]
    s_barrier
    ds_read_b128 a[32:35], v16 offset:0
    v_exp_f32 v2, v48
    v_exp_f32_e64 v3, v49
    v_mfma_f32_32x32x16_bf16 v[32:47], a[36:39], a[4:7], v[32:47]
    ds_read_b128 a[36:39], v17 offset:0
    v_add_f32_e64 v11, v2, v3
    v_cvt_pk_bf16_f32 v72, v2, v3
    v_exp_f32_e64 v4, v50
    v_mfma_f32_32x32x16_bf16 v[32:47], a[40:43], a[8:11], v[32:47]
    ds_read_b128 a[40:43], v18 offset:0
    v_add_f32 v11, v11, v4
    v_exp_f32 v5, v51
    v_exp_f32_e64 v6, v52
    v_mfma_f32_32x32x16_bf16 v[32:47], a[44:47], a[12:15], v[32:47]
    ds_read_b128 a[44:47], v19 offset:0
    v_add_f32 v11, v11, v5
    v_add_f32 v11, v11, v6
    v_cvt_pk_bf16_f32 v73, v4, v5
    v_exp_f32_e64 v7, v53
    v_mfma_f32_32x32x16_bf16 v[32:47], a[48:51], a[16:19], v[32:47]
    ds_read_b128 a[48:51], v20 offset:0
    v_add_f32_e64 v11, v11, v7
    v_cvt_pk_bf16_f32 v74, v6, v7
    v_exp_f32_e64 v8, v54
    v_mfma_f32_32x32x16_bf16 v[32:47], a[52:55], a[20:23], v[32:47]
    ds_read_b128 a[52:55], v21 offset:0
    v_add_f32 v11, v11, v8
    v_exp_f32 v9, v55
    v_exp_f32_e64 v2, v56
    v_mfma_f32_32x32x16_bf16 v[32:47], a[56:59], a[24:27], v[32:47]
    ds_read_b128 a[56:59], v22 offset:0
    v_add_f32 v11, v11, v9
    v_add_f32 v11, v11, v2
    v_cvt_pk_bf16_f32 v75, v8, v9
    v_exp_f32_e64 v3, v57
    v_mfma_f32_32x32x16_bf16 v[32:47], a[60:63], a[28:31], v[32:47]
    ds_read_b128 a[60:63], v23 offset:0
    v_add_f32_e64 v11, v11, v3
    v_cvt_pk_bf16_f32 v76, v2, v3
    v_exp_f32 v4, v58
    s_waitcnt lgkmcnt(8)
    v_mfma_f32_32x32x16_bf16 v[96:111], a[64:67], v[64:67], v[96:111]
    ds_read_b64_tr_b16 a[64:65], v24 offset:24576
    ds_read_b64_tr_b16 a[66:67], v24 offset:26624
    v_add_f32 v11, v11, v4
    v_exp_f32 v5, v59
    v_mfma_f32_32x32x16_bf16 v[112:127], a[68:71], v[64:67], v[112:127]
    ds_read_b64_tr_b16 a[68:69], v25 offset:24576
    ds_read_b64_tr_b16 a[70:71], v25 offset:26624
    v_add_f32_e64 v11, v11, v5
    v_cvt_pk_bf16_f32 v77, v4, v5
    v_exp_f32_e64 v6, v60
    v_mfma_f32_32x32x16_bf16 v[128:143], a[72:75], v[64:67], v[128:143]
    ds_read_b64_tr_b16 a[72:73], v26 offset:24576
    ds_read_b64_tr_b16 a[74:75], v26 offset:26624
    v_add_f32 v11, v11, v6
    v_exp_f32 v7, v61
    v_mfma_f32_32x32x16_bf16 v[144:159], a[76:79], v[64:67], v[144:159]
    ds_read_b64_tr_b16 a[76:77], v27 offset:24576
    ds_read_b64_tr_b16 a[78:79], v27 offset:26624
    v_add_f32_e64 v11, v11, v7
    v_cvt_pk_bf16_f32 v78, v6, v7
    v_exp_f32_e64 v8, v62
    v_mfma_f32_32x32x16_bf16 v[96:111], a[80:83], v[68:71], v[96:111]
    ds_read_b64_tr_b16 a[80:81], v24 offset:28672
    ds_read_b64_tr_b16 a[82:83], v24 offset:30720
    v_add_f32 v11, v11, v8
    v_exp_f32 v9, v63
    v_mfma_f32_32x32x16_bf16 v[112:127], a[84:87], v[68:71], v[112:127]
    ds_read_b64_tr_b16 a[84:85], v25 offset:28672
    ds_read_b64_tr_b16 a[86:87], v25 offset:30720
    v_add_f32_e64 v11, v11, v9
    v_cvt_pk_bf16_f32 v79, v8, v9
    v_mfma_f32_32x32x16_bf16 v[128:143], a[88:91], v[68:71], v[128:143]
    v_cmp_lt_f32 vcc, s67, v11
    ds_read_b64_tr_b16 a[88:89], v26 offset:28672
    ds_read_b64_tr_b16 a[90:91], v26 offset:30720
    v_mfma_f32_32x32x16_bf16 v[144:159], a[92:95], v[68:71], v[144:159]
    ds_read_b64_tr_b16 a[92:93], v27 offset:28672
    ds_read_b64_tr_b16 a[94:95], v27 offset:30720
    s_cbranch_vccnz L_rare_3
L_back_3:
    v_add_f32 v10, v10, v11
    s_waitcnt lgkmcnt(15)
    v_mfma_f32_32x32x16_bf16 v[48:63], a[32:35], a[0:3], v[80:95]
    s_barrier
    ds_read_b128 a[32:35], v16 offset:40960
    v_exp_f32 v2, v32
    v_exp_f32_e64 v3, v33
    v_mfma_f32_32x32x16_bf16 v[48:63], a[36:39], a[4:7], v[48:63]
    ds_read_b128 a[36:39], v17 offset:40960
    v_add_f32_e64 v11, v2, v3
    v_cvt_pk_bf16_f32 v64, v2, v3
    v_exp_f32_e64 v4, v34
    v_mfma_f32_32x32x16_bf16 v[48:63], a[40:43], a[8:11], v[48:63]
    ds_read_b128 a[40:43], v18 offset:40960
    v_add_f32 v11, v11, v4
    v_exp_f32 v5, v35
    v_exp_f32_e64 v6, v36
    v_mfma_f32_32x32x16_bf16 v[48:63], a[44:47], a[12:15], v[48:63]
    ds_read_b128 a[44:47], v19 offset:40960
    v_add_f32 v11, v11, v5
    v_add_f32 v11, v11, v6
    v_cvt_pk_bf16_f32 v65, v4, v5
    v_exp_f32_e64 v7, v37
    v_mfma_f32_32x32x16_bf16 v[48:63], a[48:51], a[16:19], v[48:63]
    ds_read_b128 a[48:51], v20 offset:40960
    v_add_f32_e64 v11, v11, v7
    v_cvt_pk_bf16_f32 v66, v6, v7
    v_exp_f32_e64 v8, v38
    v_mfma_f32_32x32x16_bf16 v[48:63], a[52:55], a[20:23], v[48:63]
    ds_read_b128 a[52:55], v21 offset:40960
    v_add_f32 v11, v11, v8
    v_exp_f32 v9, v39
    v_exp_f32_e64 v2, v40
    v_mfma_f32_32x32x16_bf16 v[48:63], a[56:59], a[24:27], v[48:63]
    ds_read_b128 a[56:59], v22 offset:40960
    v_add_f32 v11, v11, v9
    v_add_f32 v11, v11, v2
    v_cvt_pk_bf16_f32 v67, v8, v9
    v_exp_f32_e64 v3, v41
    v_mfma_f32_32x32x16_bf16 v[48:63], a[60:63], a[28:31], v[48:63]
    ds_read_b128 a[60:63], v23 offset:40960
    v_add_f32_e64 v11, v11, v3
    v_cvt_pk_bf16_f32 v68, v2, v3
    v_exp_f32 v4, v42
    s_waitcnt lgkmcnt(8)
    v_mfma_f32_32x32x16_bf16 v[96:111], a[64:67], v[72:75], v[96:111]
    ds_read_b64_tr_b16 a[64:65], v24 offset:32768
    ds_read_b64_tr_b16 a[66:67], v24 offset:34816
    v_add_f32 v11, v11, v4
    v_exp_f32 v5, v43
    v_mfma_f32_32x32x16_bf16 v[112:127], a[68:71], v[72:75], v[112:127]
    ds_read_b64_tr_b16 a[68:69], v25 offset:32768
    ds_read_b64_tr_b16 a[70:71], v25 offset:34816
    v_add_f32_e64 v11, v11, v5
    v_cvt_pk_bf16_f32 v69, v4, v5
    v_exp_f32_e64 v6, v44
    v_mfma_f32_32x32x16_bf16 v[128:143], a[72:75], v[72:75], v[128:143]
    ds_read_b64_tr_b16 a[72:73], v26 offset:32768
    ds_read_b64_tr_b16 a[74:75], v26 offset:34816
    v_add_f32 v11, v11, v6
    v_exp_f32 v7, v45
    v_mfma_f32_32x32x16_bf16 v[144:159], a[76:79], v[72:75], v[144:159]
    ds_read_b64_tr_b16 a[76:77], v27 offset:32768
    ds_read_b64_tr_b16 a[78:79], v27 offset:34816
    v_add_f32_e64 v11, v11, v7
    v_cvt_pk_bf16_f32 v70, v6, v7
    v_exp_f32_e64 v8, v46
    v_mfma_f32_32x32x16_bf16 v[96:111], a[80:83], v[76:79], v[96:111]
    ds_read_b64_tr_b16 a[80:81], v24 offset:36864
    ds_read_b64_tr_b16 a[82:83], v24 offset:38912
    v_add_f32 v11, v11, v8
    v_exp_f32 v9, v47
    v_mfma_f32_32x32x16_bf16 v[112:127], a[84:87], v[76:79], v[112:127]
    ds_read_b64_tr_b16 a[84:85], v25 offset:36864
    ds_read_b64_tr_b16 a[86:87], v25 offset:38912
    v_add_f32_e64 v11, v11, v9
    v_cvt_pk_bf16_f32 v71, v8, v9
    v_mfma_f32_32x32x16_bf16 v[128:143], a[88:91], v[76:79], v[128:143]
    v_cmp_lt_f32 vcc, s67, v11
    ds_read_b64_tr_b16 a[88:89], v26 offset:36864
    ds_read_b64_tr_b16 a[90:91], v26 offset:38912
    v_mfma_f32_32x32x16_bf16 v[144:159], a[92:95], v[76:79], v[144:159]
    ds_read_b64_tr_b16 a[92:93], v27 offset:36864
    ds_read_b64_tr_b16 a[94:95], v27 offset:38912
    s_cbranch_vccnz L_rare_4
L_back_4:
    v_add_f32 v10, v10, v11
    s_waitcnt lgkmcnt(15)
    v_mfma_f32_32x32x16_bf16 v[32:47], a[32:35], a[0:3], v[80:95]
    s_barrier
    ds_read_b128 a[32:35], v16 offset:32768
    v_exp_f32 v2, v48
    v_exp_f32_e64 v3, v49
    v_mfma_f32_32x32x16_bf16 v[32:47], a[36:39], a[4:7], v[32:47]
    ds_read_b128 a[36:39], v17 offset:32768
    v_add_f32_e64 v11, v2, v3
    v_cvt_pk_bf16_f32 v72, v2, v3
    v_exp_f32_e64 v4, v50
    v_mfma_f32_32x32x16_bf16 v[32:47], a[40:43], a[8:11], v[32:47]
    ds_read_b128 a[40:43], v18 offset:32768
    v_add_f32 v11, v11, v4
    v_exp_f32 v5, v51
    v_exp_f32_e64 v6, v52
    v_mfma_f32_32x32x16_bf16 v[32:47], a[44:47], a[12:15], v[32:47]
    ds_read_b128 a[44:47], v19 offset:32768
    v_add_f32 v11, v11, v5
    v_add_f32 v11, v11, v6
    v_cvt_pk_bf16_f32 v73, v4, v5
    v_exp_f32_e64 v7, v53
    v_mfma_f32_32x32x16_bf16 v[32:47], a[48:51], a[16:19], v[32:47]
    ds_read_b128 a[48:51], v20 offset:32768
    v_add_f32_e64 v11, v11, v7
    v_cvt_pk_bf16_f32 v74, v6, v7
    v_exp_f32_e64 v8, v54
    v_mfma_f32_32x32x16_bf16 v[32:47], a[52:55], a[20:23], v[32:47]
    ds_read_b128 a[52:55], v21 offset:32768
    v_add_f32 v11, v11, v8
    v_exp_f32 v9, v55
    v_exp_f32_e64 v2, v56
    v_mfma_f32_32x32x16_bf16 v[32:47], a[56:59], a[24:27], v[32:47]
    ds_read_b128 a[56:59], v22 offset:32768
    v_add_f32 v11, v11, v9
    v_add_f32 v11, v11, v2
    v_cvt_pk_bf16_f32 v75, v8, v9
    v_exp_f32_e64 v3, v57
    v_mfma_f32_32x32x16_bf16 v[32:47], a[60:63], a[28:31], v[32:47]
    ds_read_b128 a[60:63], v23 offset:32768
    v_add_f32_e64 v11, v11, v3
    v_cvt_pk_bf16_f32 v76, v2, v3
    v_exp_f32 v4, v58
    s_waitcnt lgkmcnt(8)
    v_mfma_f32_32x32x16_bf16 v[96:111], a[64:67], v[64:67], v[96:111]
    ds_read_b64_tr_b16 a[64:65], v24 offset:40960
    ds_read_b64_tr_b16 a[66:67], v24 offset:43008
    v_add_f32 v11, v11, v4
    v_exp_f32 v5, v59
    v_mfma_f32_32x32x16_bf16 v[112:127], a[68:71], v[64:67], v[112:127]
    ds_read_b64_tr_b16 a[68:69], v25 offset:40960
    ds_read_b64_tr_b16 a[70:71], v25 offset:43008
    v_add_f32_e64 v11, v11, v5
    v_cvt_pk_bf16_f32 v77, v4, v5
    v_exp_f32_e64 v6, v60
    v_mfma_f32_32x32x16_bf16 v[128:143], a[72:75], v[64:67], v[128:143]
    ds_read_b64_tr_b16 a[72:73], v26 offset:40960
    ds_read_b64_tr_b16 a[74:75], v26 offset:43008
    v_add_f32 v11, v11, v6
    v_exp_f32 v7, v61
    v_mfma_f32_32x32x16_bf16 v[144:159], a[76:79], v[64:67], v[144:159]
    ds_read_b64_tr_b16 a[76:77], v27 offset:40960
    ds_read_b64_tr_b16 a[78:79], v27 offset:43008
    v_add_f32_e64 v11, v11, v7
    v_cvt_pk_bf16_f32 v78, v6, v7
    v_exp_f32_e64 v8, v62
    v_mfma_f32_32x32x16_bf16 v[96:111], a[80:83], v[68:71], v[96:111]
    ds_read_b64_tr_b16 a[80:81], v24 offset:45056
    ds_read_b64_tr_b16 a[82:83], v24 offset:47104
    v_add_f32 v11, v11, v8
    v_exp_f32 v9, v63
    v_mfma_f32_32x32x16_bf16 v[112:127], a[84:87], v[68:71], v[112:127]
    ds_read_b64_tr_b16 a[84:85], v25 offset:45056
    ds_read_b64_tr_b16 a[86:87], v25 offset:47104
    v_add_f32_e64 v11, v11, v9
    v_cvt_pk_bf16_f32 v79, v8, v9
    v_mfma_f32_32x32x16_bf16 v[128:143], a[88:91], v[68:71], v[128:143]
    v_cmp_lt_f32 vcc, s67, v11
    ds_read_b64_tr_b16 a[88:89], v26 offset:45056
    ds_read_b64_tr_b16 a[90:91], v26 offset:47104
    v_mfma_f32_32x32x16_bf16 v[144:159], a[92:95], v[68:71], v[144:159]
    ds_read_b64_tr_b16 a[92:93], v27 offset:45056
    ds_read_b64_tr_b16 a[94:95], v27 offset:47104
    s_cbranch_vccnz L_rare_5
L_back_5:
    v_add_f32 v10, v10, v11
    s_waitcnt lgkmcnt(15)
    v_mfma_f32_32x32x16_bf16 v[48:63], a[32:35], a[0:3], v[80:95]
    s_barrier
    ds_read_b128 a[32:35], v16 offset:24576
    v_exp_f32 v2, v32
    v_exp_f32_e64 v3, v33
    v_mfma_f32_32x32x16_bf16 v[48:63], a[36:39], a[4:7], v[48:63]
    ds_read_b128 a[36:39], v17 offset:24576
    v_add_f32_e64 v11, v2, v3
    v_cvt_pk_bf16_f32 v64, v2, v3
    v_exp_f32_e64 v4, v34
    v_mfma_f32_32x32x16_bf16 v[48:63], a[40:43], a[8:11], v[48:63]
    ds_read_b128 a[40:43], v18 offset:24576
    v_add_f32 v11, v11, v4
    v_exp_f32 v5, v35
    v_exp_f32_e64 v6, v36
    v_mfma_f32_32x32x16_bf16 v[48:63], a[44:47], a[12:15], v[48:63]
    ds_read_b128 a[44:47], v19 offset:24576
    v_add_f32 v11, v11, v5
    v_add_f32 v11, v11, v6
    v_cvt_pk_bf16_f32 v65, v4, v5
    v_exp_f32_e64 v7, v37
    v_mfma_f32_32x32x16_bf16 v[48:63], a[48:51], a[16:19], v[48:63]
    ds_read_b128 a[48:51], v20 offset:24576
    v_add_f32_e64 v11, v11, v7
    v_cvt_pk_bf16_f32 v66, v6, v7
    v_exp_f32_e64 v8, v38
    v_mfma_f32_32x32x16_bf16 v[48:63], a[52:55], a[20:23], v[48:63]
    ds_read_b128 a[52:55], v21 offset:24576
    v_add_f32 v11, v11, v8
    v_exp_f32 v9, v39
    v_exp_f32_e64 v2, v40
    v_mfma_f32_32x32x16_bf16 v[48:63], a[56:59], a[24:27], v[48:63]
    ds_read_b128 a[56:59], v22 offset:24576
    v_add_f32 v11, v11, v9
    v_add_f32 v11, v11, v2
    v_cvt_pk_bf16_f32 v67, v8, v9
    v_exp_f32_e64 v3, v41
    v_mfma_f32_32x32x16_bf16 v[48:63], a[60:63], a[28:31], v[48:63]
    ds_read_b128 a[60:63], v23 offset:24576
    v_add_f32_e64 v11, v11, v3
    v_cvt_pk_bf16_f32 v68, v2, v3
    v_exp_f32 v4, v42
    s_waitcnt lgkmcnt(8)
    v_mfma_f32_32x32x16_bf16 v[96:111], a[64:67], v[72:75], v[96:111]
    ds_read_b64_tr_b16 a[64:65], v24 offset:0
    ds_read_b64_tr_b16 a[66:67], v24 offset:2048
    v_add_f32 v11, v11, v4
    v_exp_f32 v5, v43
    v_mfma_f32_32x32x16_bf16 v[112:127], a[68:71], v[72:75], v[112:127]
    ds_read_b64_tr_b16 a[68:69], v25 offset:0
    ds_read_b64_tr_b16 a[70:71], v25 offset:2048
    v_add_f32_e64 v11, v11, v5
    v_cvt_pk_bf16_f32 v69, v4, v5
    v_exp_f32_e64 v6, v44
    v_mfma_f32_32x32x16_bf16 v[128:143], a[72:75], v[72:75], v[128:143]
    ds_read_b64_tr_b16 a[72:73], v26 offset:0
    ds_read_b64_tr_b16 a[74:75], v26 offset:2048
    v_add_f32 v11, v11, v6
    v_exp_f32 v7, v45
    v_mfma_f32_32x32x16_bf16 v[144:159], a[76:79], v[72:75], v[144:159]
    ds_read_b64_tr_b16 a[76:77], v27 offset:0
    ds_read_b64_tr_b16 a[78:79], v27 offset:2048
    v_add_f32_e64 v11, v11, v7
    v_cvt_pk_bf16_f32 v70, v6, v7
    v_exp_f32_e64 v8, v46
    v_mfma_f32_32x32x16_bf16 v[96:111], a[80:83], v[76:79], v[96:111]
    ds_read_b64_tr_b16 a[80:81], v24 offset:4096
    ds_read_b64_tr_b16 a[82:83], v24 offset:6144
    v_add_f32 v11, v11, v8
    v_exp_f32 v9, v47
    v_mfma_f32_32x32x16_bf16 v[112:127], a[84:87], v[76:79], v[112:127]
    ds_read_b64_tr_b16 a[84:85], v25 offset:4096
    ds_read_b64_tr_b16 a[86:87], v25 offset:6144
    v_add_f32_e64 v11, v11, v9
    v_cvt_pk_bf16_f32 v71, v8, v9
    v_mfma_f32_32x32x16_bf16 v[128:143], a[88:91], v[76:79], v[128:143]
    v_cmp_lt_f32 vcc, s67, v11
    ds_read_b64_tr_b16 a[88:89], v26 offset:4096
    ds_read_b64_tr_b16 a[90:91], v26 offset:6144
    v_mfma_f32_32x32x16_bf16 v[144:159], a[92:95], v[76:79], v[144:159]
    ds_read_b64_tr_b16 a[92:93], v27 offset:4096
    ds_read_b64_tr_b16 a[94:95], v27 offset:6144
    s_cbranch_vccnz L_rare_6
L_back_6:
    v_add_f32 v10, v10, v11
    s_waitcnt lgkmcnt(15)
    s_sub_u32 s64, s64, 1
    s_cmp_lg_u32 s64, 0
    s_cbranch_scc1 L_p2_loop
    s_nop 0
    s_barrier
    v_exp_f32 v2, v48
    v_exp_f32 v3, v49
    s_nop 0
    v_add_f32_e64 v11, v2, v3
    v_cvt_pk_bf16_f32 v72, v2, v3
    v_exp_f32 v4, v50
    v_exp_f32 v5, v51
    s_nop 0
    v_add_f32 v11, v11, v4
    v_add_f32_e64 v11, v11, v5
    v_cvt_pk_bf16_f32 v73, v4, v5
    v_exp_f32 v6, v52
    s_nop 0
    v_add_f32 v11, v11, v6
    v_exp_f32 v7, v53
    v_exp_f32 v8, v54
    s_nop 0
    v_add_f32 v11, v11, v7
    v_add_f32 v11, v11, v8
    v_cvt_pk_bf16_f32 v74, v6, v7
    v_exp_f32 v9, v55
    s_nop 0
    v_add_f32_e64 v11, v11, v9
    v_cvt_pk_bf16_f32 v75, v8, v9
    v_exp_f32 v2, v56
    v_exp_f32 v3, v57
    s_nop 0
    v_add_f32 v11, v11, v2
    v_add_f32_e64 v11, v11, v3
    v_cvt_pk_bf16_f32 v76, v2, v3
    v_exp_f32 v4, v58
    s_nop 0
    v_add_f32 v11, v11, v4
    v_exp_f32 v5, v59
    v_exp_f32 v6, v60
    s_waitcnt lgkmcnt(0)
    v_mfma_f32_32x32x16_bf16 v[96:111], a[64:67], v[64:67], v[96:111]
    ds_read_b64_tr_b16 a[64:65], v24 offset:8192
    ds_read_b64_tr_b16 a[66:67], v24 offset:10240
    v_add_f32 v11, v11, v5
    v_add_f32 v11, v11, v6
    v_cvt_pk_bf16_f32 v77, v4, v5
    v_mfma_f32_32x32x16_bf16 v[112:127], a[68:71], v[64:67], v[112:127]
    ds_read_b64_tr_b16 a[68:69], v25 offset:8192
    ds_read_b64_tr_b16 a[70:71], v25 offset:10240
    v_exp_f32 v7, v61
    v_exp_f32 v8, v62
    v_mfma_f32_32x32x16_bf16 v[128:143], a[72:75], v[64:67], v[128:143]
    ds_read_b64_tr_b16 a[72:73], v26 offset:8192
    ds_read_b64_tr_b16 a[74:75], v26 offset:10240
    v_add_f32 v11, v11, v7
    v_add_f32 v11, v11, v8
    v_cvt_pk_bf16_f32 v78, v6, v7
    v_mfma_f32_32x32x16_bf16 v[144:159], a[76:79], v[64:67], v[144:159]
    ds_read_b64_tr_b16 a[76:77], v27 offset:8192
    ds_read_b64_tr_b16 a[78:79], v27 offset:10240
    v_exp_f32_e64 v9, v63
    v_mfma_f32_32x32x16_bf16 v[96:111], a[80:83], v[68:71], v[96:111]
    ds_read_b64_tr_b16 a[80:81], v24 offset:12288
    ds_read_b64_tr_b16 a[82:83], v24 offset:14336
    v_add_f32_e64 v11, v11, v9
    v_cvt_pk_bf16_f32 v79, v8, v9
    v_mfma_f32_32x32x16_bf16 v[112:127], a[84:87], v[68:71], v[112:127]
    v_cmp_lt_f32 vcc, s67, v11
    ds_read_b64_tr_b16 a[84:85], v25 offset:12288
    ds_read_b64_tr_b16 a[86:87], v25 offset:14336
    v_mfma_f32_32x32x16_bf16 v[128:143], a[88:91], v[68:71], v[128:143]
    ds_read_b64_tr_b16 a[88:89], v26 offset:12288
    ds_read_b64_tr_b16 a[90:91], v26 offset:14336
    v_mfma_f32_32x32x16_bf16 v[144:159], a[92:95], v[68:71], v[144:159]
    ds_read_b64_tr_b16 a[92:93], v27 offset:12288
    ds_read_b64_tr_b16 a[94:95], v27 offset:14336
    s_cbranch_vccnz L_rare_31
L_back_31:
    v_add_f32 v10, v10, v11
    s_waitcnt lgkmcnt(15)
    v_mov_b32 v8, v10
    s_nop 1
    v_permlane32_swap_b32 v8, v10
    v_add_f32 v10, v10, v8
    v_rcp_f32 v8, v10
    s_waitcnt lgkmcnt(0)
    v_mov_b32 v9, v8
    s_barrier
    v_mfma_f32_32x32x16_bf16 v[96:111], a[64:67], v[72:75], v[96:111]
    v_xor_b32 v32, 0, v28
    v_xor_b32 v33, 16, v28
    v_xor_b32 v34, 32, v28
    v_xor_b32 v35, 48, v28
    v_mfma_f32_32x32x16_bf16 v[96:111], a[80:83], v[76:79], v[96:111]
    v_xor_b32_e64 v36, 64, v28
    v_xor_b32 v37, 80, v28
    v_xor_b32 v38, 96, v28
    v_xor_b32 v39, 112, v28
    v_mfma_f32_32x32x16_bf16 v[112:127], a[68:71], v[72:75], v[112:127]
    v_xor_b32 v40, 128, v28
    v_xor_b32 v41, 144, v28
    v_xor_b32 v42, 160, v28
    v_xor_b32 v43, 176, v28
    v_mfma_f32_32x32x16_bf16 v[112:127], a[84:87], v[76:79], v[112:127]
    v_xor_b32 v44, 192, v28
    v_xor_b32 v45, 208, v28
    v_xor_b32 v46, 224, v28
    v_xor_b32 v47, 240, v28
    v_xor_b32 v2, 0, v30
    v_xor_b32 v3, 32, v30
    v_xor_b32_e64 v4, 64, v30
    v_xor_b32 v5, 96, v30
    s_mul_i32 s63, s3, 12288
    v_add_u32 v10, s88, v2
    v_add_u32 v11, s88, v3
    v_add_u32 v12, s88, v4
    v_add_u32 v13, s88, v5
    v_pk_mul_f32 v[96:97], v[96:97], v[8:9]
    v_pk_mul_f32 v[98:99], v[98:99], v[8:9]
    v_cvt_pk_bf16_f32 v96, v96, v97
    v_cvt_pk_bf16_f32 v97, v98, v99
    ds_write_b64 v32, v[96:97]
    v_pk_mul_f32 v[100:101], v[100:101], v[8:9]
    v_pk_mul_f32 v[102:103], v[102:103], v[8:9]
    v_cvt_pk_bf16_f32 v100, v100, v101
    v_cvt_pk_bf16_f32 v101, v102, v103
    ds_write_b64 v33, v[100:101]
    v_mfma_f32_32x32x16_bf16 v[128:143], a[72:75], v[72:75], v[128:143]
    v_pk_mul_f32 v[104:105], v[104:105], v[8:9]
    v_pk_mul_f32 v[106:107], v[106:107], v[8:9]
    v_cvt_pk_bf16_f32 v104, v104, v105
    v_cvt_pk_bf16_f32 v105, v106, v107
    ds_write_b64 v34, v[104:105]
    v_pk_mul_f32 v[108:109], v[108:109], v[8:9]
    v_pk_mul_f32 v[110:111], v[110:111], v[8:9]
    v_cvt_pk_bf16_f32 v108, v108, v109
    v_cvt_pk_bf16_f32 v109, v110, v111
    ds_write_b64 v35, v[108:109]
    v_mfma_f32_32x32x16_bf16 v[128:143], a[88:91], v[76:79], v[128:143]
    v_pk_mul_f32 v[112:113], v[112:113], v[8:9]
    v_pk_mul_f32 v[114:115], v[114:115], v[8:9]
    v_cvt_pk_bf16_f32 v112, v112, v113
    v_cvt_pk_bf16_f32 v113, v114, v115
    ds_write_b64 v36, v[112:113]
    v_pk_mul_f32 v[116:117], v[116:117], v[8:9]
    v_pk_mul_f32 v[118:119], v[118:119], v[8:9]
    v_cvt_pk_bf16_f32 v116, v116, v117
    v_cvt_pk_bf16_f32 v117, v118, v119
    ds_write_b64 v37, v[116:117]
    v_mfma_f32_32x32x16_bf16 v[144:159], a[76:79], v[72:75], v[144:159]
    v_pk_mul_f32 v[120:121], v[120:121], v[8:9]
    v_pk_mul_f32 v[122:123], v[122:123], v[8:9]
    v_cvt_pk_bf16_f32 v120, v120, v121
    v_cvt_pk_bf16_f32 v121, v122, v123
    ds_write_b64 v38, v[120:121]
    v_pk_mul_f32 v[124:125], v[124:125], v[8:9]
    v_pk_mul_f32 v[126:127], v[126:127], v[8:9]
    v_cvt_pk_bf16_f32 v124, v124, v125
    v_cvt_pk_bf16_f32 v125, v126, v127
    ds_write_b64 v39, v[124:125]
    v_mfma_f32_32x32x16_bf16 v[144:159], a[92:95], v[76:79], v[144:159]
    v_add_u32 v16, s89, v2
    v_add_u32 v17, s89, v3
    v_add_u32 v18, s89, v4
    v_add_u32 v19, s89, v5
    v_add_u32 v20, s90, v2
    v_add_u32 v21, s90, v3
    v_add_u32 v22, s90, v4
    v_add_u32 v23, s90, v5
    v_add_u32 v24, s91, v2
    v_add_u32 v25, s91, v3
    v_add_u32 v26, s91, v4
    v_add_u32 v27, s91, v5
    s_add_u32 s60, s31, 0
    s_and_b32 s60, s60, 7
    s_lshl_b32 s60, s60, 6
    v_xor_b32 v14, s60, v29
    s_add_u32 s60, s31, 1
    s_and_b32 s60, s60, 7
    s_lshl_b32 s60, s60, 6
    v_xor_b32 v15, s60, v29
    v_pk_mul_f32 v[128:129], v[128:129], v[8:9]
    v_pk_mul_f32 v[130:131], v[130:131], v[8:9]
    v_cvt_pk_bf16_f32 v128, v128, v129
    v_cvt_pk_bf16_f32 v129, v130, v131
    ds_write_b64 v40, v[128:129]
    v_pk_mul_f32 v[132:133], v[132:133], v[8:9]
    v_pk_mul_f32 v[134:135], v[134:135], v[8:9]
    v_cvt_pk_bf16_f32 v132, v132, v133
    v_cvt_pk_bf16_f32 v133, v134, v135
    ds_write_b64 v41, v[132:133]
    v_pk_mul_f32 v[136:137], v[136:137], v[8:9]
    v_pk_mul_f32 v[138:139], v[138:139], v[8:9]
    v_cvt_pk_bf16_f32 v136, v136, v137
    v_cvt_pk_bf16_f32 v137, v138, v139
    ds_write_b64 v42, v[136:137]
    v_pk_mul_f32 v[140:141], v[140:141], v[8:9]
    v_pk_mul_f32 v[142:143], v[142:143], v[8:9]
    v_cvt_pk_bf16_f32 v140, v140, v141
    v_cvt_pk_bf16_f32 v141, v142, v143
    ds_write_b64 v43, v[140:141]
    v_pk_mul_f32 v[144:145], v[144:145], v[8:9]
    v_pk_mul_f32 v[146:147], v[146:147], v[8:9]
    v_cvt_pk_bf16_f32 v144, v144, v145
    v_cvt_pk_bf16_f32 v145, v146, v147
    ds_write_b64 v44, v[144:145]
    v_pk_mul_f32 v[148:149], v[148:149], v[8:9]
    v_pk_mul_f32 v[150:151], v[150:151], v[8:9]
    v_cvt_pk_bf16_f32 v148, v148, v149
    v_cvt_pk_bf16_f32 v149, v150, v151
    ds_write_b64 v45, v[148:149]
    v_pk_mul_f32 v[152:153], v[152:153], v[8:9]
    v_pk_mul_f32 v[154:155], v[154:155], v[8:9]
    v_cvt_pk_bf16_f32 v152, v152, v153
    v_cvt_pk_bf16_f32 v153, v154, v155
    ds_write_b64 v46, v[152:153]
    v_pk_mul_f32 v[156:157], v[156:157], v[8:9]
    v_pk_mul_f32 v[158:159], v[158:159], v[8:9]
    v_cvt_pk_bf16_f32 v156, v156, v157
    v_cvt_pk_bf16_f32 v157, v158, v159
    ds_write_b64 v47, v[156:157]
L_p3:
    s_waitcnt lgkmcnt(0)
    s_barrier
    ds_read_b128 a[0:3], v14 offset:0
    ds_read_b128 a[4:7], v14 offset:8192
    ds_read_b128 a[8:11], v14 offset:16384
    ds_read_b64_tr_b16 v[32:33], v10 offset:0
    ds_read_b64_tr_b16 v[34:35], v10 offset:512
    ds_read_b64_tr_b16 v[36:37], v11 offset:0
    ds_read_b64_tr_b16 v[38:39], v11 offset:512
    ds_read_b64_tr_b16 v[40:41], v12 offset:0
    ds_read_b64_tr_b16 v[42:43], v12 offset:512
    ds_read_b64_tr_b16 v[44:45], v13 offset:0
    ds_read_b64_tr_b16 v[46:47], v13 offset:512
    s_waitcnt lgkmcnt(6)
    v_mfma_f32_16x16x32_bf16 v[64:67], v[32:35], a[0:3], 0
    ds_read_b128 a[12:15], v15 offset:0
    ds_read_b128 a[16:19], v15 offset:8192
    v_mfma_f32_16x16x32_bf16 v[68:71], v[32:35], a[4:7], 0
    ds_read_b128 a[20:23], v15 offset:16384
    v_mfma_f32_16x16x32_bf16 v[72:75], v[32:35], a[8:11], 0
    ds_read_b64_tr_b16 v[48:49], v10 offset:4096
    s_waitcnt lgkmcnt(8)
    v_mfma_f32_16x16x32_bf16 v[76:79], v[36:39], a[0:3], 0
    ds_read_b64_tr_b16 v[50:51], v10 offset:4608
    v_mfma_f32_16x16x32_bf16 v[80:83], v[36:39], a[4:7], 0
    ds_read_b64_tr_b16 v[52:53], v11 offset:4096
    ds_read_b64_tr_b16 v[54:55], v11 offset:4608
    v_mfma_f32_16x16x32_bf16 v[84:87], v[36:39], a[8:11], 0
    ds_read_b64_tr_b16 v[56:57], v12 offset:4096
    s_waitcnt lgkmcnt(10)
    v_mfma_f32_16x16x32_bf16 v[88:91], v[40:43], a[0:3], 0
    ds_read_b64_tr_b16 v[58:59], v12 offset:4608
    v_mfma_f32_16x16x32_bf16 v[92:95], v[40:43], a[4:7], 0
    ds_read_b64_tr_b16 v[60:61], v13 offset:4096
    v_mfma_f32_16x16x32_bf16 v[96:99], v[40:43], a[8:11], 0
    ds_read_b64_tr_b16 v[62:63], v13 offset:4608
    s_waitcnt lgkmcnt(11)
    v_mfma_f32_16x16x32_bf16 v[100:103], v[44:47], a[0:3], 0
    s_add_u32 s60, s31, 2
    s_and_b32 s60, s60, 7
    s_lshl_b32 s60, s60, 6
    v_xor_b32 v14, s60, v29
    v_mfma_f32_16x16x32_bf16 v[104:107], v[44:47], a[4:7], 0
    v_mfma_f32_16x16x32_bf16 v[108:111], v[44:47], a[8:11], 0
    s_barrier
    s_waitcnt lgkmcnt(6)
    v_mfma_f32_16x16x32_bf16 v[64:67], v[48:51], a[12:15], v[64:67]
    ds_read_b128 a[24:27], v14 offset:0
    ds_read_b128 a[28:31], v14 offset:8192
    v_mfma_f32_16x16x32_bf16 v[68:71], v[48:51], a[16:19], v[68:71]
    ds_read_b128 a[32:35], v14 offset:16384
    v_mfma_f32_16x16x32_bf16 v[72:75], v[48:51], a[20:23], v[72:75]
    ds_read_b64_tr_b16 v[32:33], v16 offset:0
    s_waitcnt lgkmcnt(8)
    v_mfma_f32_16x16x32_bf16 v[76:79], v[52:55], a[12:15], v[76:79]
    ds_read_b64_tr_b16 v[34:35], v16 offset:512
    v_mfma_f32_16x16x32_bf16 v[80:83], v[52:55], a[16:19], v[80:83]
    ds_read_b64_tr_b16 v[36:37], v17 offset:0
    ds_read_b64_tr_b16 v[38:39], v17 offset:512
    v_mfma_f32_16x16x32_bf16 v[84:87], v[52:55], a[20:23], v[84:87]
    ds_read_b64_tr_b16 v[40:41], v18 offset:0
    s_waitcnt lgkmcnt(10)
    v_mfma_f32_16x16x32_bf16 v[88:91], v[56:59], a[12:15], v[88:91]
    ds_read_b64_tr_b16 v[42:43], v18 offset:512
    v_mfma_f32_16x16x32_bf16 v[92:95], v[56:59], a[16:19], v[92:95]
    ds_read_b64_tr_b16 v[44:45], v19 offset:0
    v_mfma_f32_16x16x32_bf16 v[96:99], v[56:59], a[20:23], v[96:99]
    ds_read_b64_tr_b16 v[46:47], v19 offset:512
    s_waitcnt lgkmcnt(11)
    v_mfma_f32_16x16x32_bf16 v[100:103], v[60:63], a[12:15], v[100:103]
    s_add_u32 s60, s31, 3
    s_and_b32 s60, s60, 7
    s_lshl_b32 s60, s60, 6
    v_xor_b32_e64 v15, s60, v29
    v_mfma_f32_16x16x32_bf16 v[104:107], v[60:63], a[16:19], v[104:107]
    v_mfma_f32_16x16x32_bf16 v[108:111], v[60:63], a[20:23], v[108:111]
    s_barrier
    s_waitcnt lgkmcnt(6)
    v_mfma_f32_16x16x32_bf16 v[64:67], v[32:35], a[24:27], v[64:67]
    ds_read_b128 a[36:39], v15 offset:0
    ds_read_b128 a[40:43], v15 offset:8192
    v_mfma_f32_16x16x32_bf16 v[68:71], v[32:35], a[28:31], v[68:71]
    ds_read_b128 a[44:47], v15 offset:16384
    v_mfma_f32_16x16x32_bf16 v[72:75], v[32:35], a[32:35], v[72:75]
    ds_read_b64_tr_b16 v[48:49], v16 offset:4096
    s_waitcnt lgkmcnt(8)
    v_mfma_f32_16x16x32_bf16 v[76:79], v[36:39], a[24:27], v[76:79]
    ds_read_b64_tr_b16 v[50:51], v16 offset:4608
    v_mfma_f32_16x16x32_bf16 v[80:83], v[36:39], a[28:31], v[80:83]
    ds_read_b64_tr_b16 v[52:53], v17 offset:4096
    ds_read_b64_tr_b16 v[54:55], v17 offset:4608
    v_mfma_f32_16x16x32_bf16 v[84:87], v[36:39], a[32:35], v[84:87]
    ds_read_b64_tr_b16 v[56:57], v18 offset:4096
    s_waitcnt lgkmcnt(10)
    v_mfma_f32_16x16x32_bf16 v[88:91], v[40:43], a[24:27], v[88:91]
    ds_read_b64_tr_b16 v[58:59], v18 offset:4608
    v_mfma_f32_16x16x32_bf16 v[92:95], v[40:43], a[28:31], v[92:95]
    ds_read_b64_tr_b16 v[60:61], v19 offset:4096
    v_mfma_f32_16x16x32_bf16 v[96:99], v[40:43], a[32:35], v[96:99]
    ds_read_b64_tr_b16 v[62:63], v19 offset:4608
    s_waitcnt lgkmcnt(11)
    v_mfma_f32_16x16x32_bf16 v[100:103], v[44:47], a[24:27], v[100:103]
    s_add_u32 s60, s31, 4
    s_and_b32 s60, s60, 7
    s_lshl_b32 s60, s60, 6
    v_xor_b32_e64 v14, s60, v29
    v_mfma_f32_16x16x32_bf16 v[104:107], v[44:47], a[28:31], v[104:107]
    v_mfma_f32_16x16x32_bf16 v[108:111], v[44:47], a[32:35], v[108:111]
    s_barrier
    s_waitcnt lgkmcnt(6)
    v_mfma_f32_16x16x32_bf16 v[64:67], v[48:51], a[36:39], v[64:67]
    ds_read_b128 a[48:51], v14 offset:0
    ds_read_b128 a[52:55], v14 offset:8192
    v_mfma_f32_16x16x32_bf16 v[68:71], v[48:51], a[40:43], v[68:71]
    ds_read_b128 a[56:59], v14 offset:16384
    v_mfma_f32_16x16x32_bf16 v[72:75], v[48:51], a[44:47], v[72:75]
    ds_read_b64_tr_b16 v[32:33], v20 offset:0
    s_waitcnt lgkmcnt(8)
    v_mfma_f32_16x16x32_bf16 v[76:79], v[52:55], a[36:39], v[76:79]
    ds_read_b64_tr_b16 v[34:35], v20 offset:512
    v_mfma_f32_16x16x32_bf16 v[80:83], v[52:55], a[40:43], v[80:83]
    ds_read_b64_tr_b16 v[36:37], v21 offset:0
    ds_read_b64_tr_b16 v[38:39], v21 offset:512
    v_mfma_f32_16x16x32_bf16 v[84:87], v[52:55], a[44:47], v[84:87]
    ds_read_b64_tr_b16 v[40:41], v22 offset:0
    s_waitcnt lgkmcnt(10)
    v_mfma_f32_16x16x32_bf16 v[88:91], v[56:59], a[36:39], v[88:91]
    ds_read_b64_tr_b16 v[42:43], v22 offset:512
    v_mfma_f32_16x16x32_bf16 v[92:95], v[56:59], a[40:43], v[92:95]
    ds_read_b64_tr_b16 v[44:45], v23 offset:0
    v_mfma_f32_16x16x32_bf16 v[96:99], v[56:59], a[44:47], v[96:99]
    ds_read_b64_tr_b16 v[46:47], v23 offset:512
    s_waitcnt lgkmcnt(11)
    v_mfma_f32_16x16x32_bf16 v[100:103], v[60:63], a[36:39], v[100:103]
    s_add_u32 s60, s31, 5
    s_and_b32 s60, s60, 7
    s_lshl_b32 s60, s60, 6
    v_xor_b32_e64 v15, s60, v29
    v_mfma_f32_16x16x32_bf16 v[104:107], v[60:63], a[40:43], v[104:107]
    v_mfma_f32_16x16x32_bf16 v[108:111], v[60:63], a[44:47], v[108:111]
    s_barrier
    s_waitcnt lgkmcnt(6)
    v_mfma_f32_16x16x32_bf16 v[64:67], v[32:35], a[48:51], v[64:67]
    ds_read_b128 a[60:63], v15 offset:0
    ds_read_b128 a[64:67], v15 offset:8192
    v_mfma_f32_16x16x32_bf16 v[68:71], v[32:35], a[52:55], v[68:71]
    ds_read_b128 a[68:71], v15 offset:16384
    v_mfma_f32_16x16x32_bf16 v[72:75], v[32:35], a[56:59], v[72:75]
    ds_read_b64_tr_b16 v[48:49], v20 offset:4096
    s_waitcnt lgkmcnt(8)
    v_mfma_f32_16x16x32_bf16 v[76:79], v[36:39], a[48:51], v[76:79]
    ds_read_b64_tr_b16 v[50:51], v20 offset:4608
    v_mfma_f32_16x16x32_bf16 v[80:83], v[36:39], a[52:55], v[80:83]
    ds_read_b64_tr_b16 v[52:53], v21 offset:4096
    ds_read_b64_tr_b16 v[54:55], v21 offset:4608
    v_mfma_f32_16x16x32_bf16 v[84:87], v[36:39], a[56:59], v[84:87]
    ds_read_b64_tr_b16 v[56:57], v22 offset:4096
    s_waitcnt lgkmcnt(10)
    v_mfma_f32_16x16x32_bf16 v[88:91], v[40:43], a[48:51], v[88:91]
    ds_read_b64_tr_b16 v[58:59], v22 offset:4608
    v_mfma_f32_16x16x32_bf16 v[92:95], v[40:43], a[52:55], v[92:95]
    ds_read_b64_tr_b16 v[60:61], v23 offset:4096
    v_mfma_f32_16x16x32_bf16 v[96:99], v[40:43], a[56:59], v[96:99]
    ds_read_b64_tr_b16 v[62:63], v23 offset:4608
    s_waitcnt lgkmcnt(11)
    v_mfma_f32_16x16x32_bf16 v[100:103], v[44:47], a[48:51], v[100:103]
    s_add_u32 s60, s31, 6
    s_and_b32 s60, s60, 7
    s_lshl_b32 s60, s60, 6
    v_xor_b32_e64 v14, s60, v29
    v_mfma_f32_16x16x32_bf16 v[104:107], v[44:47], a[52:55], v[104:107]
    v_mfma_f32_16x16x32_bf16 v[108:111], v[44:47], a[56:59], v[108:111]
    s_barrier
    s_waitcnt lgkmcnt(6)
    v_mfma_f32_16x16x32_bf16 v[64:67], v[48:51], a[60:63], v[64:67]
    ds_read_b128 a[72:75], v14 offset:0
    ds_read_b128 a[76:79], v14 offset:8192
    v_mfma_f32_16x16x32_bf16 v[68:71], v[48:51], a[64:67], v[68:71]
    ds_read_b128 a[80:83], v14 offset:16384
    v_mfma_f32_16x16x32_bf16 v[72:75], v[48:51], a[68:71], v[72:75]
    ds_read_b64_tr_b16 v[32:33], v24 offset:0
    s_waitcnt lgkmcnt(8)
    v_mfma_f32_16x16x32_bf16 v[76:79], v[52:55], a[60:63], v[76:79]
    ds_read_b64_tr_b16 v[34:35], v24 offset:512
    v_mfma_f32_16x16x32_bf16 v[80:83], v[52:55], a[64:67], v[80:83]
    ds_read_b64_tr_b16 v[36:37], v25 offset:0
    ds_read_b64_tr_b16 v[38:39], v25 offset:512
    v_mfma_f32_16x16x32_bf16 v[84:87], v[52:55], a[68:71], v[84:87]
    ds_read_b64_tr_b16 v[40:41], v26 offset:0
    s_waitcnt lgkmcnt(10)
    v_mfma_f32_16x16x32_bf16 v[88:91], v[56:59], a[60:63], v[88:91]
    ds_read_b64_tr_b16 v[42:43], v26 offset:512
    v_mfma_f32_16x16x32_bf16 v[92:95], v[56:59], a[64:67], v[92:95]
    ds_read_b64_tr_b16 v[44:45], v27 offset:0
    v_mfma_f32_16x16x32_bf16 v[96:99], v[56:59], a[68:71], v[96:99]
    ds_read_b64_tr_b16 v[46:47], v27 offset:512
    s_waitcnt lgkmcnt(11)
    v_mfma_f32_16x16x32_bf16 v[100:103], v[60:63], a[60:63], v[100:103]
    s_add_u32 s60, s31, 7
    s_and_b32 s60, s60, 7
    s_lshl_b32 s60, s60, 6
    v_xor_b32_e64 v15, s60, v29
    v_mfma_f32_16x16x32_bf16 v[104:107], v[60:63], a[64:67], v[104:107]
    v_mfma_f32_16x16x32_bf16 v[108:111], v[60:63], a[68:71], v[108:111]
    s_barrier
    s_waitcnt lgkmcnt(6)
    v_mfma_f32_16x16x32_bf16 v[64:67], v[32:35], a[72:75], v[64:67]
    ds_read_b128 a[84:87], v15 offset:0
    ds_read_b128 a[88:91], v15 offset:8192
    v_mfma_f32_16x16x32_bf16 v[68:71], v[32:35], a[76:79], v[68:71]
    ds_read_b128 a[92:95], v15 offset:16384
    v_mfma_f32_16x16x32_bf16 v[72:75], v[32:35], a[80:83], v[72:75]
    ds_read_b64_tr_b16 v[48:49], v24 offset:4096
    s_waitcnt lgkmcnt(8)
    v_mfma_f32_16x16x32_bf16 v[76:79], v[36:39], a[72:75], v[76:79]
    ds_read_b64_tr_b16 v[50:51], v24 offset:4608
    v_mfma_f32_16x16x32_bf16 v[80:83], v[36:39], a[76:79], v[80:83]
    ds_read_b64_tr_b16 v[52:53], v25 offset:4096
    ds_read_b64_tr_b16 v[54:55], v25 offset:4608
    v_mfma_f32_16x16x32_bf16 v[84:87], v[36:39], a[80:83], v[84:87]
    ds_read_b64_tr_b16 v[56:57], v26 offset:4096
    s_waitcnt lgkmcnt(10)
    v_mfma_f32_16x16x32_bf16 v[88:91], v[40:43], a[72:75], v[88:91]
    ds_read_b64_tr_b16 v[58:59], v26 offset:4608
    v_mfma_f32_16x16x32_bf16 v[92:95], v[40:43], a[76:79], v[92:95]
    ds_read_b64_tr_b16 v[60:61], v27 offset:4096
    v_mfma_f32_16x16x32_bf16 v[96:99], v[40:43], a[80:83], v[96:99]
    ds_read_b64_tr_b16 v[62:63], v27 offset:4608
    s_waitcnt lgkmcnt(11)
    v_mfma_f32_16x16x32_bf16 v[100:103], v[44:47], a[72:75], v[100:103]
    v_mfma_f32_16x16x32_bf16 v[104:107], v[44:47], a[76:79], v[104:107]
    v_mfma_f32_16x16x32_bf16 v[108:111], v[44:47], a[80:83], v[108:111]
    s_barrier
    s_waitcnt lgkmcnt(6)
    v_mfma_f32_16x16x32_bf16 v[64:67], v[48:51], a[84:87], v[64:67]
    ds_read_b64_tr_b16 v[32:33], v10 offset:0
    v_mfma_f32_16x16x32_bf16 v[68:71], v[48:51], a[88:91], v[68:71]
    ds_read_b64_tr_b16 v[34:35], v10 offset:512
    v_mfma_f32_16x16x32_bf16 v[72:75], v[48:51], a[92:95], v[72:75]
    ds_read_b64_tr_b16 v[36:37], v11 offset:0
    s_waitcnt lgkmcnt(7)
    v_mfma_f32_16x16x32_bf16 v[76:79], v[52:55], a[84:87], v[76:79]
    ds_read_b64_tr_b16 v[38:39], v11 offset:512
    v_mfma_f32_16x16x32_bf16 v[80:83], v[52:55], a[88:91], v[80:83]
    ds_read_b64_tr_b16 v[40:41], v12 offset:0
    v_mfma_f32_16x16x32_bf16 v[84:87], v[52:55], a[92:95], v[84:87]
    ds_read_b64_tr_b16 v[42:43], v12 offset:512
    s_waitcnt lgkmcnt(8)
    v_mfma_f32_16x16x32_bf16 v[88:91], v[56:59], a[84:87], v[88:91]
    ds_read_b64_tr_b16 v[44:45], v13 offset:0
    v_mfma_f32_16x16x32_bf16 v[92:95], v[56:59], a[88:91], v[92:95]
    ds_read_b64_tr_b16 v[46:47], v13 offset:512
    v_mfma_f32_16x16x32_bf16 v[96:99], v[56:59], a[92:95], v[96:99]
    s_waitcnt lgkmcnt(8)
    v_mfma_f32_16x16x32_bf16 v[100:103], v[60:63], a[84:87], v[100:103]
    v_mfma_f32_16x16x32_bf16 v[104:107], v[60:63], a[88:91], v[104:107]
    v_mfma_f32_16x16x32_bf16 v[108:111], v[60:63], a[92:95], v[108:111]
    s_barrier
    s_waitcnt lgkmcnt(6)
    v_mfma_f32_16x16x32_bf16 v[112:115], v[32:35], a[0:3], 0
    ds_read_b64_tr_b16 v[48:49], v10 offset:4096
    v_mfma_f32_16x16x32_bf16 v[116:119], v[32:35], a[4:7], 0
    ds_read_b64_tr_b16 v[50:51], v10 offset:4608
    v_mfma_f32_16x16x32_bf16 v[120:123], v[32:35], a[8:11], 0
    ds_read_b64_tr_b16 v[52:53], v11 offset:4096
    s_waitcnt lgkmcnt(7)
    v_mfma_f32_16x16x32_bf16 v[124:127], v[36:39], a[0:3], 0
    ds_read_b64_tr_b16 v[54:55], v11 offset:4608
    v_mfma_f32_16x16x32_bf16 v[128:131], v[36:39], a[4:7], 0
    ds_read_b64_tr_b16 v[56:57], v12 offset:4096
    v_mfma_f32_16x16x32_bf16 v[132:135], v[36:39], a[8:11], 0
    ds_read_b64_tr_b16 v[58:59], v12 offset:4608
    s_waitcnt lgkmcnt(8)
    v_mfma_f32_16x16x32_bf16 v[136:139], v[40:43], a[0:3], 0
    ds_read_b64_tr_b16 v[60:61], v13 offset:4096
    v_mfma_f32_16x16x32_bf16 v[140:143], v[40:43], a[4:7], 0
    ds_read_b64_tr_b16 v[62:63], v13 offset:4608
    v_mfma_f32_16x16x32_bf16 v[144:147], v[40:43], a[8:11], 0
    s_waitcnt lgkmcnt(8)
    v_mfma_f32_16x16x32_bf16 v[148:151], v[44:47], a[0:3], 0
    v_mfma_f32_16x16x32_bf16 v[152:155], v[44:47], a[4:7], 0
    v_mfma_f32_16x16x32_bf16 v[156:159], v[44:47], a[8:11], 0
    s_barrier
    s_waitcnt lgkmcnt(6)
    v_mfma_f32_16x16x32_bf16 v[112:115], v[48:51], a[12:15], v[112:115]
    ds_read_b64_tr_b16 v[32:33], v16 offset:0
    v_mfma_f32_16x16x32_bf16 v[116:119], v[48:51], a[16:19], v[116:119]
    ds_read_b64_tr_b16 v[34:35], v16 offset:512
    v_mfma_f32_16x16x32_bf16 v[120:123], v[48:51], a[20:23], v[120:123]
    ds_read_b64_tr_b16 v[36:37], v17 offset:0
    s_waitcnt lgkmcnt(7)
    v_mfma_f32_16x16x32_bf16 v[124:127], v[52:55], a[12:15], v[124:127]
    ds_read_b64_tr_b16 v[38:39], v17 offset:512
    v_mfma_f32_16x16x32_bf16 v[128:131], v[52:55], a[16:19], v[128:131]
    ds_read_b64_tr_b16 v[40:41], v18 offset:0
    v_mfma_f32_16x16x32_bf16 v[132:135], v[52:55], a[20:23], v[132:135]
    ds_read_b64_tr_b16 v[42:43], v18 offset:512
    s_waitcnt lgkmcnt(8)
    v_mfma_f32_16x16x32_bf16 v[136:139], v[56:59], a[12:15], v[136:139]
    ds_read_b64_tr_b16 v[44:45], v19 offset:0
    v_mfma_f32_16x16x32_bf16 v[140:143], v[56:59], a[16:19], v[140:143]
    ds_read_b64_tr_b16 v[46:47], v19 offset:512
    v_mfma_f32_16x16x32_bf16 v[144:147], v[56:59], a[20:23], v[144:147]
    s_waitcnt lgkmcnt(8)
    v_mfma_f32_16x16x32_bf16 v[148:151], v[60:63], a[12:15], v[148:151]
    v_mfma_f32_16x16x32_bf16 v[152:155], v[60:63], a[16:19], v[152:155]
    v_cvt_pk_bf16_f32 v2, v64, v65
    v_cvt_pk_bf16_f32 v3, v66, v67
    v_cvt_pk_bf16_f32 v4, v76, v77
    v_cvt_pk_bf16_f32 v5, v78, v79
    s_add_u32 s62, s63, 0
    buffer_store_dwordx4 v[2:5], v31, s[24:27], s62 offen offset:0 sc1
    v_mfma_f32_16x16x32_bf16 v[156:159], v[60:63], a[20:23], v[156:159]
    s_barrier
    s_waitcnt lgkmcnt(6)
    v_mfma_f32_16x16x32_bf16 v[112:115], v[32:35], a[24:27], v[112:115]
    ds_read_b64_tr_b16 v[48:49], v16 offset:4096
    v_mfma_f32_16x16x32_bf16 v[116:119], v[32:35], a[28:31], v[116:119]
    ds_read_b64_tr_b16 v[50:51], v16 offset:4608
    v_mfma_f32_16x16x32_bf16 v[120:123], v[32:35], a[32:35], v[120:123]
    ds_read_b64_tr_b16 v[52:53], v17 offset:4096
    s_waitcnt lgkmcnt(7)
    v_mfma_f32_16x16x32_bf16 v[124:127], v[36:39], a[24:27], v[124:127]
    ds_read_b64_tr_b16 v[54:55], v17 offset:4608
    v_mfma_f32_16x16x32_bf16 v[128:131], v[36:39], a[28:31], v[128:131]
    ds_read_b64_tr_b16 v[56:57], v18 offset:4096
    v_mfma_f32_16x16x32_bf16 v[132:135], v[36:39], a[32:35], v[132:135]
    ds_read_b64_tr_b16 v[58:59], v18 offset:4608
    s_waitcnt lgkmcnt(8)
    v_mfma_f32_16x16x32_bf16 v[136:139], v[40:43], a[24:27], v[136:139]
    ds_read_b64_tr_b16 v[60:61], v19 offset:4096
    v_mfma_f32_16x16x32_bf16 v[140:143], v[40:43], a[28:31], v[140:143]
    ds_read_b64_tr_b16 v[62:63], v19 offset:4608
    v_mfma_f32_16x16x32_bf16 v[144:147], v[40:43], a[32:35], v[144:147]
    s_waitcnt lgkmcnt(8)
    v_mfma_f32_16x16x32_bf16 v[148:151], v[44:47], a[24:27], v[148:151]
    v_mfma_f32_16x16x32_bf16 v[152:155], v[44:47], a[28:31], v[152:155]
    v_cvt_pk_bf16_f32 v6, v68, v69
    v_cvt_pk_bf16_f32 v7, v70, v71
    v_cvt_pk_bf16_f32 v8, v80, v81
    v_cvt_pk_bf16_f32 v9, v82, v83
    s_add_u32 s62, s63, 4096
    buffer_store_dwordx4 v[6:9], v31, s[24:27], s62 offen offset:0 sc1
    v_mfma_f32_16x16x32_bf16 v[156:159], v[44:47], a[32:35], v[156:159]
    s_barrier
    s_waitcnt lgkmcnt(6)
    v_mfma_f32_16x16x32_bf16 v[112:115], v[48:51], a[36:39], v[112:115]
    ds_read_b64_tr_b16 v[32:33], v20 offset:0
    v_mfma_f32_16x16x32_bf16 v[116:119], v[48:51], a[40:43], v[116:119]
    ds_read_b64_tr_b16 v[34:35], v20 offset:512
    v_mfma_f32_16x16x32_bf16 v[120:123], v[48:51], a[44:47], v[120:123]
    ds_read_b64_tr_b16 v[36:37], v21 offset:0
    s_waitcnt lgkmcnt(7)
    v_mfma_f32_16x16x32_bf16 v[124:127], v[52:55], a[36:39], v[124:127]
    ds_read_b64_tr_b16 v[38:39], v21 offset:512
    v_mfma_f32_16x16x32_bf16 v[128:131], v[52:55], a[40:43], v[128:131]
    ds_read_b64_tr_b16 v[40:41], v22 offset:0
    v_mfma_f32_16x16x32_bf16 v[132:135], v[52:55], a[44:47], v[132:135]
    ds_read_b64_tr_b16 v[42:43], v22 offset:512
    s_waitcnt lgkmcnt(8)
    v_mfma_f32_16x16x32_bf16 v[136:139], v[56:59], a[36:39], v[136:139]
    ds_read_b64_tr_b16 v[44:45], v23 offset:0
    v_mfma_f32_16x16x32_bf16 v[140:143], v[56:59], a[40:43], v[140:143]
    ds_read_b64_tr_b16 v[46:47], v23 offset:512
    v_mfma_f32_16x16x32_bf16 v[144:147], v[56:59], a[44:47], v[144:147]
    s_waitcnt lgkmcnt(8)
    v_mfma_f32_16x16x32_bf16 v[148:151], v[60:63], a[36:39], v[148:151]
    v_mfma_f32_16x16x32_bf16 v[152:155], v[60:63], a[40:43], v[152:155]
    v_cvt_pk_bf16_f32 v2, v72, v73
    v_cvt_pk_bf16_f32 v3, v74, v75
    v_cvt_pk_bf16_f32 v4, v84, v85
    v_cvt_pk_bf16_f32 v5, v86, v87
    s_add_u32 s62, s63, 8192
    buffer_store_dwordx4 v[2:5], v31, s[24:27], s62 offen offset:0 sc1
    v_mfma_f32_16x16x32_bf16 v[156:159], v[60:63], a[44:47], v[156:159]
    s_barrier
    s_waitcnt lgkmcnt(6)
    v_mfma_f32_16x16x32_bf16 v[112:115], v[32:35], a[48:51], v[112:115]
    ds_read_b64_tr_b16 v[48:49], v20 offset:4096
    v_mfma_f32_16x16x32_bf16 v[116:119], v[32:35], a[52:55], v[116:119]
    ds_read_b64_tr_b16 v[50:51], v20 offset:4608
    v_mfma_f32_16x16x32_bf16 v[120:123], v[32:35], a[56:59], v[120:123]
    ds_read_b64_tr_b16 v[52:53], v21 offset:4096
    s_waitcnt lgkmcnt(7)
    v_mfma_f32_16x16x32_bf16 v[124:127], v[36:39], a[48:51], v[124:127]
    ds_read_b64_tr_b16 v[54:55], v21 offset:4608
    v_mfma_f32_16x16x32_bf16 v[128:131], v[36:39], a[52:55], v[128:131]
    ds_read_b64_tr_b16 v[56:57], v22 offset:4096
    v_mfma_f32_16x16x32_bf16 v[132:135], v[36:39], a[56:59], v[132:135]
    ds_read_b64_tr_b16 v[58:59], v22 offset:4608
    s_waitcnt lgkmcnt(8)
    v_mfma_f32_16x16x32_bf16 v[136:139], v[40:43], a[48:51], v[136:139]
    ds_read_b64_tr_b16 v[60:61], v23 offset:4096
    v_mfma_f32_16x16x32_bf16 v[140:143], v[40:43], a[52:55], v[140:143]
    ds_read_b64_tr_b16 v[62:63], v23 offset:4608
    v_mfma_f32_16x16x32_bf16 v[144:147], v[40:43], a[56:59], v[144:147]
    s_waitcnt lgkmcnt(8)
    v_mfma_f32_16x16x32_bf16 v[148:151], v[44:47], a[48:51], v[148:151]
    v_mfma_f32_16x16x32_bf16 v[152:155], v[44:47], a[52:55], v[152:155]
    v_cvt_pk_bf16_f32 v6, v88, v89
    v_cvt_pk_bf16_f32 v7, v90, v91
    v_cvt_pk_bf16_f32 v8, v100, v101
    v_cvt_pk_bf16_f32 v9, v102, v103
    s_add_u32 s62, s63, 0
    buffer_store_dwordx4 v[6:9], v31, s[24:27], s62 offen offset:1024 sc1
    v_mfma_f32_16x16x32_bf16 v[156:159], v[44:47], a[56:59], v[156:159]
    s_barrier
    s_waitcnt lgkmcnt(6)
    v_mfma_f32_16x16x32_bf16 v[112:115], v[48:51], a[60:63], v[112:115]
    ds_read_b64_tr_b16 v[32:33], v24 offset:0
    v_mfma_f32_16x16x32_bf16 v[116:119], v[48:51], a[64:67], v[116:119]
    ds_read_b64_tr_b16 v[34:35], v24 offset:512
    v_mfma_f32_16x16x32_bf16 v[120:123], v[48:51], a[68:71], v[120:123]
    ds_read_b64_tr_b16 v[36:37], v25 offset:0
    s_waitcnt lgkmcnt(7)
    v_mfma_f32_16x16x32_bf16 v[124:127], v[52:55], a[60:63], v[124:127]
    ds_read_b64_tr_b16 v[38:39], v25 offset:512
    v_mfma_f32_16x16x32_bf16 v[128:131], v[52:55], a[64:67], v[128:131]
    ds_read_b64_tr_b16 v[40:41], v26 offset:0
    v_mfma_f32_16x16x32_bf16 v[132:135], v[52:55], a[68:71], v[132:135]
    ds_read_b64_tr_b16 v[42:43], v26 offset:512
    s_waitcnt lgkmcnt(8)
    v_mfma_f32_16x16x32_bf16 v[136:139], v[56:59], a[60:63], v[136:139]
    ds_read_b64_tr_b16 v[44:45], v27 offset:0
    v_mfma_f32_16x16x32_bf16 v[140:143], v[56:59], a[64:67], v[140:143]
    ds_read_b64_tr_b16 v[46:47], v27 offset:512
    v_mfma_f32_16x16x32_bf16 v[144:147], v[56:59], a[68:71], v[144:147]
    s_waitcnt lgkmcnt(8)
    v_mfma_f32_16x16x32_bf16 v[148:151], v[60:63], a[60:63], v[148:151]
    v_mfma_f32_16x16x32_bf16 v[152:155], v[60:63], a[64:67], v[152:155]
    v_cvt_pk_bf16_f32 v2, v92, v93
    v_cvt_pk_bf16_f32 v3, v94, v95
    v_cvt_pk_bf16_f32 v4, v104, v105
    v_cvt_pk_bf16_f32 v5, v106, v107
    s_add_u32 s62, s63, 4096
    buffer_store_dwordx4 v[2:5], v31, s[24:27], s62 offen offset:1024 sc1
    v_mfma_f32_16x16x32_bf16 v[156:159], v[60:63], a[68:71], v[156:159]
    s_barrier
    s_waitcnt lgkmcnt(6)
    v_mfma_f32_16x16x32_bf16 v[112:115], v[32:35], a[72:75], v[112:115]
    ds_read_b64_tr_b16 v[48:49], v24 offset:4096
    v_mfma_f32_16x16x32_bf16 v[116:119], v[32:35], a[76:79], v[116:119]
    ds_read_b64_tr_b16 v[50:51], v24 offset:4608
    v_mfma_f32_16x16x32_bf16 v[120:123], v[32:35], a[80:83], v[120:123]
    ds_read_b64_tr_b16 v[52:53], v25 offset:4096
    s_waitcnt lgkmcnt(7)
    v_mfma_f32_16x16x32_bf16 v[124:127], v[36:39], a[72:75], v[124:127]
    ds_read_b64_tr_b16 v[54:55], v25 offset:4608
    v_mfma_f32_16x16x32_bf16 v[128:131], v[36:39], a[76:79], v[128:131]
    ds_read_b64_tr_b16 v[56:57], v26 offset:4096
    v_mfma_f32_16x16x32_bf16 v[132:135], v[36:39], a[80:83], v[132:135]
    ds_read_b64_tr_b16 v[58:59], v26 offset:4608
    s_waitcnt lgkmcnt(8)
    v_mfma_f32_16x16x32_bf16 v[136:139], v[40:43], a[72:75], v[136:139]
    ds_read_b64_tr_b16 v[60:61], v27 offset:4096
    v_mfma_f32_16x16x32_bf16 v[140:143], v[40:43], a[76:79], v[140:143]
    ds_read_b64_tr_b16 v[62:63], v27 offset:4608
    v_mfma_f32_16x16x32_bf16 v[144:147], v[40:43], a[80:83], v[144:147]
    s_waitcnt lgkmcnt(8)
    v_mfma_f32_16x16x32_bf16 v[148:151], v[44:47], a[72:75], v[148:151]
    v_mfma_f32_16x16x32_bf16 v[152:155], v[44:47], a[76:79], v[152:155]
    v_cvt_pk_bf16_f32 v6, v96, v97
    v_cvt_pk_bf16_f32 v7, v98, v99
    v_cvt_pk_bf16_f32 v8, v108, v109
    v_cvt_pk_bf16_f32 v9, v110, v111
    s_add_u32 s62, s63, 8192
    buffer_store_dwordx4 v[6:9], v31, s[24:27], s62 offen offset:1024 sc1
    v_mfma_f32_16x16x32_bf16 v[156:159], v[44:47], a[80:83], v[156:159]
    s_barrier
    s_waitcnt lgkmcnt(6)
    v_mfma_f32_16x16x32_bf16 v[112:115], v[48:51], a[84:87], v[112:115]
    v_mfma_f32_16x16x32_bf16 v[116:119], v[48:51], a[88:91], v[116:119]
    v_mfma_f32_16x16x32_bf16 v[120:123], v[48:51], a[92:95], v[120:123]
    s_waitcnt lgkmcnt(4)
    v_mfma_f32_16x16x32_bf16 v[124:127], v[52:55], a[84:87], v[124:127]
    v_mfma_f32_16x16x32_bf16 v[128:131], v[52:55], a[88:91], v[128:131]
    v_mfma_f32_16x16x32_bf16 v[132:135], v[52:55], a[92:95], v[132:135]
    s_waitcnt lgkmcnt(2)
    v_mfma_f32_16x16x32_bf16 v[136:139], v[56:59], a[84:87], v[136:139]
    v_mfma_f32_16x16x32_bf16 v[140:143], v[56:59], a[88:91], v[140:143]
    v_mfma_f32_16x16x32_bf16 v[144:147], v[56:59], a[92:95], v[144:147]
    s_waitcnt lgkmcnt(0)
    v_mfma_f32_16x16x32_bf16 v[148:151], v[60:63], a[84:87], v[148:151]
    v_cvt_pk_bf16_f32 v2, v112, v113
    v_cvt_pk_bf16_f32 v3, v114, v115
    v_cvt_pk_bf16_f32 v4, v124, v125
    v_cvt_pk_bf16_f32 v5, v126, v127
    s_add_u32 s62, s63, 0
    buffer_store_dwordx4 v[2:5], v31, s[24:27], s62 offen offset:2048 sc1
    v_mfma_f32_16x16x32_bf16 v[152:155], v[60:63], a[88:91], v[152:155]
    v_cvt_pk_bf16_f32 v6, v116, v117
    v_cvt_pk_bf16_f32 v7, v118, v119
    v_cvt_pk_bf16_f32 v8, v128, v129
    v_cvt_pk_bf16_f32 v9, v130, v131
    s_add_u32 s62, s63, 4096
    buffer_store_dwordx4 v[6:9], v31, s[24:27], s62 offen offset:2048 sc1
    v_mfma_f32_16x16x32_bf16 v[156:159], v[60:63], a[92:95], v[156:159]
    v_cvt_pk_bf16_f32 v2, v120, v121
    v_cvt_pk_bf16_f32 v3, v122, v123
    v_cvt_pk_bf16_f32 v4, v132, v133
    v_cvt_pk_bf16_f32 v5, v134, v135
    s_add_u32 s62, s63, 8192
    buffer_store_dwordx4 v[2:5], v31, s[24:27], s62 offen offset:2048 sc1
    s_nop 7
    v_cvt_pk_bf16_f32 v6, v136, v137
    v_cvt_pk_bf16_f32 v7, v138, v139
    v_cvt_pk_bf16_f32 v8, v148, v149
    v_cvt_pk_bf16_f32 v9, v150, v151
    s_add_u32 s62, s63, 0
    buffer_store_dwordx4 v[6:9], v31, s[24:27], s62 offen offset:3072 sc1
    v_cvt_pk_bf16_f32 v2, v140, v141
    v_cvt_pk_bf16_f32 v3, v142, v143
    v_cvt_pk_bf16_f32 v4, v152, v153
    v_cvt_pk_bf16_f32 v5, v154, v155
    s_add_u32 s62, s63, 4096
    buffer_store_dwordx4 v[2:5], v31, s[24:27], s62 offen offset:3072 sc1
    v_cvt_pk_bf16_f32 v6, v144, v145
    v_cvt_pk_bf16_f32 v7, v146, v147
    v_cvt_pk_bf16_f32 v8, v156, v157
    v_cvt_pk_bf16_f32 v9, v158, v159
    s_add_u32 s62, s63, 8192
    buffer_store_dwordx4 v[6:9], v31, s[24:27], s62 offen offset:3072 sc1
    s_mul_i32 s62, s93, 3
    s_add_u32 s62, s62, s3
    s_mov_b32 s4, s52
    s_and_b32 s5, s53, 0xffff
    s_mov_b32 s6, 12582912
    s_mov_b32 s7, 0x20000
    s_mov_b32 s8, s96
    s_and_b32 s9, s97, 0xffff
    s_mov_b32 s10, 786432
    s_mov_b32 s11, 0x20000
    s_mov_b32 s36, s52
    s_and_b32 s37, s53, 0xffff
    s_mov_b32 s38, 14811136
    s_mov_b32 s39, 0x20000
    s_mul_i32 s12, s92, 786432
    s_lshl_b32 s63, s62, 10
    s_add_u32 s12, s12, s63
    s_mul_i32 s13, s62, 43
    s_lshr_b32 s13, s13, 9
    s_mul_i32 s14, s13, 12
    s_sub_u32 s14, s62, s14
    s_lshr_b32 s15, s14, 2
    s_and_b32 s14, s14, 3
    s_mul_i32 s16, s56, 98304
    s_lshl_b32 s17, s57, 10
    s_add_u32 s16, s16, s17
    s_lshl_b32 s17, s15, 15
    s_add_u32 s16, s16, s17
    s_lshl_b32 s17, s13, 8
    s_add_u32 s16, s16, s17
    s_lshl_b32 s17, s14, 6
    s_add_u32 s16, s16, s17
    v_lshlrev_b32 v12, 4, v1
    v_and_b32 v13, 15, v1
    v_lshrrev_b32 v14, 4, v1
    v_lshlrev_b32 v13, 11, v13
    v_lshl_add_u32 v13, v14, 3, v13
    s_lshl_b32 s18, s92, 13
    s_add_u32 s18, s18, 14680064
    s_lshl_b32 s19, s93, 2
    s_add_u32 s19, s19, s3
    s_lshl_b32 s19, s19, 7
    s_add_u32 s19, s19, s18
    s_lshl_b32 s20, s13, 7
    s_add_u32 s20, s20, s18
    v_and_b32 v15, 15, v1
    v_lshlrev_b32 v15, 9, v15
    v_add_u32 v15, s20, v15
    v_mov_b32 v10, s19
    v_mov_b32 v11, 1
    s_waitcnt vmcnt(0)
    s_mov_b64 exec, 1
    buffer_store_dword v11, v10, s[36:39], 0 offen sc1
    s_mov_b64 exec, -1
    s_cmp_ge_u32 s3, 3
    s_cbranch_scc1 L_red_done
    s_mov_b32 s64, 0
    s_mov_b32 s22, 0
L_poll:
    s_mov_b64 exec, 0xffff
    buffer_load_dword v10, v15, s[36:39], 0 offen sc1
    s_add_u32 s64, s64, 1
    s_waitcnt vmcnt(0)
    v_cmp_eq_u32 vcc, 1, v10
    s_mov_b64 exec, -1
    s_cmp_ge_u32 s64, 0x40000
    s_cselect_b32 s23, 0xffff, vcc_lo
    s_andn2_b32 s23, s23, s22
    s_cbranch_scc0 L_poll_next
    s_bitcmp1_b32 s23, 0
    s_cbranch_scc0 L_skip0
    s_add_u32 s21, s12, 0
    buffer_load_dwordx4 v[16:19], v12, s[4:7], s21 offen sc1
L_skip0:
    s_bitcmp1_b32 s23, 1
    s_cbranch_scc0 L_skip1
    s_add_u32 s21, s12, 49152
    buffer_load_dwordx4 v[20:23], v12, s[4:7], s21 offen sc1
L_skip1:
    s_bitcmp1_b32 s23, 2
    s_cbranch_scc0 L_skip2
    s_add_u32 s21, s12, 98304
    buffer_load_dwordx4 v[24:27], v12, s[4:7], s21 offen sc1
L_skip2:
    s_bitcmp1_b32 s23, 3
    s_cbranch_scc0 L_skip3
    s_add_u32 s21, s12, 147456
    buffer_load_dwordx4 v[28:31], v12, s[4:7], s21 offen sc1
L_skip3:
    s_bitcmp1_b32 s23, 4
    s_cbranch_scc0 L_skip4
    s_add_u32 s21, s12, 196608
    buffer_load_dwordx4 v[32:35], v12, s[4:7], s21 offen sc1
L_skip4:
    s_bitcmp1_b32 s23, 5
    s_cbranch_scc0 L_skip5
    s_add_u32 s21, s12, 245760
    buffer_load_dwordx4 v[36:39], v12, s[4:7], s21 offen sc1
L_skip5:
    s_bitcmp1_b32 s23, 6
    s_cbranch_scc0 L_skip6
    s_add_u32 s21, s12, 294912
    buffer_load_dwordx4 v[40:43], v12, s[4:7], s21 offen sc1
L_skip6:
    s_bitcmp1_b32 s23, 7
    s_cbranch_scc0 L_skip7
    s_add_u32 s21, s12, 344064
    buffer_load_dwordx4 v[44:47], v12, s[4:7], s21 offen sc1
L_skip7:
    s_bitcmp1_b32 s23, 8
    s_cbranch_scc0 L_skip8
    s_add_u32 s21, s12, 393216
    buffer_load_dwordx4 v[48:51], v12, s[4:7], s21 offen sc1
L_skip8:
    s_bitcmp1_b32 s23, 9
    s_cbranch_scc0 L_skip9
    s_add_u32 s21, s12, 442368
    buffer_load_dwordx4 v[52:55], v12, s[4:7], s21 offen sc1
L_skip9:
    s_bitcmp1_b32 s23, 10
    s_cbranch_scc0 L_skip10
    s_add_u32 s21, s12, 491520
    buffer_load_dwordx4 v[56:59], v12, s[4:7], s21 offen sc1
L_skip10:
    s_bitcmp1_b32 s23, 11
    s_cbranch_scc0 L_skip11
    s_add_u32 s21, s12, 540672
    buffer_load_dwordx4 v[60:63], v12, s[4:7], s21 offen sc1
L_skip11:
    s_bitcmp1_b32 s23, 12
    s_cbranch_scc0 L_skip12
    s_add_u32 s21, s12, 589824
    buffer_load_dwordx4 v[64:67], v12, s[4:7], s21 offen sc1
L_skip12:
    s_bitcmp1_b32 s23, 13
    s_cbranch_scc0 L_skip13
    s_add_u32 s21, s12, 638976
    buffer_load_dwordx4 v[68:71], v12, s[4:7], s21 offen sc1
L_skip13:
    s_bitcmp1_b32 s23, 14
    s_cbranch_scc0 L_skip14
    s_add_u32 s21, s12, 688128
    buffer_load_dwordx4 v[72:75], v12, s[4:7], s21 offen sc1
L_skip14:
    s_bitcmp1_b32 s23, 15
    s_cbranch_scc0 L_skip15
    s_add_u32 s21, s12, 737280
    buffer_load_dwordx4 v[76:79], v12, s[4:7], s21 offen sc1
L_skip15:
    s_or_b32 s22, s22, s23
    s_cmp_eq_u32 s22, 0xffff
    s_cbranch_scc1 L_poll_done
L_poll_next:
    s_sleep 1
    s_branch L_poll
L_poll_done:
    s_waitcnt vmcnt(0)
    s_mov_b32 s22, 0x00003f80
    s_mov_b32 s23, 0x3f800000
    v_mov_b32 v2, 0
    v_mov_b32 v3, 0
    v_mov_b32 v4, 0
    v_mov_b32 v5, 0
    v_mov_b32 v6, 0
    v_mov_b32 v7, 0
    v_mov_b32 v8, 0
    v_mov_b32 v9, 0
    v_dot2c_f32_bf16 v2, s22, v16
    v_dot2c_f32_bf16 v3, s23, v16
    v_dot2c_f32_bf16 v4, s22, v17
    v_dot2c_f32_bf16 v5, s23, v17
    v_dot2c_f32_bf16 v6, s22, v18
    v_dot2c_f32_bf16 v7, s23, v18
    v_dot2c_f32_bf16 v8, s22, v19
    v_dot2c_f32_bf16 v9, s23, v19
    v_dot2c_f32_bf16 v2, s22, v20
    v_dot2c_f32_bf16 v3, s23, v20
    v_dot2c_f32_bf16 v4, s22, v21
    v_dot2c_f32_bf16 v5, s23, v21
    v_dot2c_f32_bf16 v6, s22, v22
    v_dot2c_f32_bf16 v7, s23, v22
    v_dot2c_f32_bf16 v8, s22, v23
    v_dot2c_f32_bf16 v9, s23, v23
    v_dot2c_f32_bf16 v2, s22, v24
    v_dot2c_f32_bf16 v3, s23, v24
    v_dot2c_f32_bf16 v4, s22, v25
    v_dot2c_f32_bf16 v5, s23, v25
    v_dot2c_f32_bf16 v6, s22, v26
    v_dot2c_f32_bf16 v7, s23, v26
    v_dot2c_f32_bf16 v8, s22, v27
    v_dot2c_f32_bf16 v9, s23, v27
    v_dot2c_f32_bf16 v2, s22, v28
    v_dot2c_f32_bf16 v3, s23, v28
    v_dot2c_f32_bf16 v4, s22, v29
    v_dot2c_f32_bf16 v5, s23, v29
    v_dot2c_f32_bf16 v6, s22, v30
    v_dot2c_f32_bf16 v7, s23, v30
    v_dot2c_f32_bf16 v8, s22, v31
    v_dot2c_f32_bf16 v9, s23, v31
    v_dot2c_f32_bf16 v2, s22, v32
    v_dot2c_f32_bf16 v3, s23, v32
    v_dot2c_f32_bf16 v4, s22, v33
    v_dot2c_f32_bf16 v5, s23, v33
    v_dot2c_f32_bf16 v6, s22, v34
    v_dot2c_f32_bf16 v7, s23, v34
    v_dot2c_f32_bf16 v8, s22, v35
    v_dot2c_f32_bf16 v9, s23, v35
    v_dot2c_f32_bf16 v2, s22, v36
    v_dot2c_f32_bf16 v3, s23, v36
    v_dot2c_f32_bf16 v4, s22, v37
    v_dot2c_f32_bf16 v5, s23, v37
    v_dot2c_f32_bf16 v6, s22, v38
    v_dot2c_f32_bf16 v7, s23, v38
    v_dot2c_f32_bf16 v8, s22, v39
    v_dot2c_f32_bf16 v9, s23, v39
    v_dot2c_f32_bf16 v2, s22, v40
    v_dot2c_f32_bf16 v3, s23, v40
    v_dot2c_f32_bf16 v4, s22, v41
    v_dot2c_f32_bf16 v5, s23, v41
    v_dot2c_f32_bf16 v6, s22, v42
    v_dot2c_f32_bf16 v7, s23, v42
    v_dot2c_f32_bf16 v8, s22, v43
    v_dot2c_f32_bf16 v9, s23, v43
    v_dot2c_f32_bf16 v2, s22, v44
    v_dot2c_f32_bf16 v3, s23, v44
    v_dot2c_f32_bf16 v4, s22, v45
    v_dot2c_f32_bf16 v5, s23, v45
    v_dot2c_f32_bf16 v6, s22, v46
    v_dot2c_f32_bf16 v7, s23, v46
    v_dot2c_f32_bf16 v8, s22, v47
    v_dot2c_f32_bf16 v9, s23, v47
    v_dot2c_f32_bf16 v2, s22, v48
    v_dot2c_f32_bf16 v3, s23, v48
    v_dot2c_f32_bf16 v4, s22, v49
    v_dot2c_f32_bf16 v5, s23, v49
    v_dot2c_f32_bf16 v6, s22, v50
    v_dot2c_f32_bf16 v7, s23, v50
    v_dot2c_f32_bf16 v8, s22, v51
    v_dot2c_f32_bf16 v9, s23, v51
    v_dot2c_f32_bf16 v2, s22, v52
    v_dot2c_f32_bf16 v3, s23, v52
    v_dot2c_f32_bf16 v4, s22, v53
    v_dot2c_f32_bf16 v5, s23, v53
    v_dot2c_f32_bf16 v6, s22, v54
    v_dot2c_f32_bf16 v7, s23, v54
    v_dot2c_f32_bf16 v8, s22, v55
    v_dot2c_f32_bf16 v9, s23, v55
    v_dot2c_f32_bf16 v2, s22, v56
    v_dot2c_f32_bf16 v3, s23, v56
    v_dot2c_f32_bf16 v4, s22, v57
    v_dot2c_f32_bf16 v5, s23, v57
    v_dot2c_f32_bf16 v6, s22, v58
    v_dot2c_f32_bf16 v7, s23, v58
    v_dot2c_f32_bf16 v8, s22, v59
    v_dot2c_f32_bf16 v9, s23, v59
    v_dot2c_f32_bf16 v2, s22, v60
    v_dot2c_f32_bf16 v3, s23, v60
    v_dot2c_f32_bf16 v4, s22, v61
    v_dot2c_f32_bf16 v5, s23, v61
    v_dot2c_f32_bf16 v6, s22, v62
    v_dot2c_f32_bf16 v7, s23, v62
    v_dot2c_f32_bf16 v8, s22, v63
    v_dot2c_f32_bf16 v9, s23, v63
    v_dot2c_f32_bf16 v2, s22, v64
    v_dot2c_f32_bf16 v3, s23, v64
    v_dot2c_f32_bf16 v4, s22, v65
    v_dot2c_f32_bf16 v5, s23, v65
    v_dot2c_f32_bf16 v6, s22, v66
    v_dot2c_f32_bf16 v7, s23, v66
    v_dot2c_f32_bf16 v8, s22, v67
    v_dot2c_f32_bf16 v9, s23, v67
    v_dot2c_f32_bf16 v2, s22, v68
    v_dot2c_f32_bf16 v3, s23, v68
    v_dot2c_f32_bf16 v4, s22, v69
    v_dot2c_f32_bf16 v5, s23, v69
    v_dot2c_f32_bf16 v6, s22, v70
    v_dot2c_f32_bf16 v7, s23, v70
    v_dot2c_f32_bf16 v8, s22, v71
    v_dot2c_f32_bf16 v9, s23, v71
    v_dot2c_f32_bf16 v2, s22, v72
    v_dot2c_f32_bf16 v3, s23, v72
    v_dot2c_f32_bf16 v4, s22, v73
    v_dot2c_f32_bf16 v5, s23, v73
    v_dot2c_f32_bf16 v6, s22, v74
    v_dot2c_f32_bf16 v7, s23, v74
    v_dot2c_f32_bf16 v8, s22, v75
    v_dot2c_f32_bf16 v9, s23, v75
    v_dot2c_f32_bf16 v2, s22, v76
    v_dot2c_f32_bf16 v3, s23, v76
    v_dot2c_f32_bf16 v4, s22, v77
    v_dot2c_f32_bf16 v5, s23, v77
    v_dot2c_f32_bf16 v6, s22, v78
    v_dot2c_f32_bf16 v7, s23, v78
    v_dot2c_f32_bf16 v8, s22, v79
    v_dot2c_f32_bf16 v9, s23, v79
    v_cvt_pk_bf16_f32 v16, v2, v3
    v_cvt_pk_bf16_f32 v17, v4, v5
    v_cvt_pk_bf16_f32 v18, v6, v7
    v_cvt_pk_bf16_f32 v19, v8, v9
    buffer_store_dwordx2 v[16:17], v13, s[8:11], s16 offen
    buffer_store_dwordx2 v[18:19], v13, s[8:11], s16 offen offset:32
L_red_done:
L_end:
    s_endpgm
L_wave3:
    s_waitcnt lgkmcnt(0)
    s_barrier
    v_lshrrev_b32 v60, 4, v1
    v_and_b32 v61, 15, v1
    v_add_u32 v24, 0, v60
    v_xor_b32 v24, v24, v61
    v_lshlrev_b32 v24, 4, v24
    v_lshl_add_u32 v24, v60, 8, v24
    v_add_u32 v25, 4, v60
    v_xor_b32 v25, v25, v61
    v_lshlrev_b32_e64 v25, 4, v25
    v_lshl_add_u32 v25, v60, 8, v25
    v_add_u32 v26, 8, v60
    v_xor_b32 v26, v26, v61
    v_lshlrev_b32_e64 v26, 4, v26
    v_lshl_add_u32 v26, v60, 8, v26
    v_add_u32 v27, 12, v60
    v_xor_b32 v27, v27, v61
    v_lshlrev_b32_e64 v27, 4, v27
    v_lshl_add_u32 v27, v60, 8, v27
    s_mov_b32 s65, 32768
    s_mov_b32 m0, 73728
    s_nop 0
    buffer_load_dwordx4 v24, s[12:15], s65 offen nt lds
    buffer_load_dwordx4 v25, s[12:15], s65 offen offset:1024 nt lds
    buffer_load_dwordx4 v26, s[12:15], s65 offen offset:2048 nt lds
    buffer_load_dwordx4 v27, s[12:15], s65 offen offset:3072 nt lds
    s_add_u32 s65, s65, 4096
    s_mov_b32 m0, 77824
    s_nop 0
    buffer_load_dwordx4 v24, s[12:15], s65 offen nt lds
    buffer_load_dwordx4 v25, s[12:15], s65 offen offset:1024 nt lds
    buffer_load_dwordx4 v26, s[12:15], s65 offen offset:2048 nt lds
    buffer_load_dwordx4 v27, s[12:15], s65 offen offset:3072 nt lds
    s_add_u32 s65, s65, 4096
    s_mov_b32 m0, 65536
    s_nop 0
    buffer_load_dwordx4 v24, s[12:15], s65 offen nt lds
    buffer_load_dwordx4 v25, s[12:15], s65 offen offset:1024 nt lds
    buffer_load_dwordx4 v26, s[12:15], s65 offen offset:2048 nt lds
    buffer_load_dwordx4 v27, s[12:15], s65 offen offset:3072 nt lds
    s_add_u32 s65, s65, 4096
    s_mov_b32 m0, 69632
    s_nop 0
    buffer_load_dwordx4 v24, s[12:15], s65 offen nt lds
    buffer_load_dwordx4 v25, s[12:15], s65 offen offset:1024 nt lds
    buffer_load_dwordx4 v26, s[12:15], s65 offen offset:2048 nt lds
    buffer_load_dwordx4 v27, s[12:15], s65 offen offset:3072 nt lds
    s_add_u32 s65, s65, 4096
    s_mov_b32 s64, 4
L_kld_loop:
    s_waitcnt vmcnt(24)
    s_barrier
    s_mov_b32 m0, 106496
    s_nop 0
    buffer_load_dwordx4 v24, s[12:15], s65 offen nt lds
    buffer_load_dwordx4 v25, s[12:15], s65 offen offset:1024 nt lds
    buffer_load_dwordx4 v26, s[12:15], s65 offen offset:2048 nt lds
    buffer_load_dwordx4 v27, s[12:15], s65 offen offset:3072 nt lds
    s_add_u32 s65, s65, 4096
    s_mov_b32 m0, 110592
    s_nop 0
    buffer_load_dwordx4 v24, s[12:15], s65 offen nt lds
    buffer_load_dwordx4 v25, s[12:15], s65 offen offset:1024 nt lds
    buffer_load_dwordx4 v26, s[12:15], s65 offen offset:2048 nt lds
    buffer_load_dwordx4 v27, s[12:15], s65 offen offset:3072 nt lds
    s_add_u32 s65, s65, 4096
    s_waitcnt vmcnt(24)
    s_barrier
    s_mov_b32 m0, 98304
    s_nop 0
    buffer_load_dwordx4 v24, s[12:15], s65 offen nt lds
    buffer_load_dwordx4 v25, s[12:15], s65 offen offset:1024 nt lds
    buffer_load_dwordx4 v26, s[12:15], s65 offen offset:2048 nt lds
    buffer_load_dwordx4 v27, s[12:15], s65 offen offset:3072 nt lds
    s_add_u32 s65, s65, 4096
    s_mov_b32 m0, 102400
    s_nop 0
    buffer_load_dwordx4 v24, s[12:15], s65 offen nt lds
    buffer_load_dwordx4 v25, s[12:15], s65 offen offset:1024 nt lds
    buffer_load_dwordx4 v26, s[12:15], s65 offen offset:2048 nt lds
    buffer_load_dwordx4 v27, s[12:15], s65 offen offset:3072 nt lds
    s_add_u32 s65, s65, 4096
    s_waitcnt vmcnt(24)
    s_barrier
    s_mov_b32 m0, 90112
    s_nop 0
    buffer_load_dwordx4 v24, s[12:15], s65 offen nt lds
    buffer_load_dwordx4 v25, s[12:15], s65 offen offset:1024 nt lds
    buffer_load_dwordx4 v26, s[12:15], s65 offen offset:2048 nt lds
    buffer_load_dwordx4 v27, s[12:15], s65 offen offset:3072 nt lds
    s_add_u32 s65, s65, 4096
    s_mov_b32 m0, 94208
    s_nop 0
    buffer_load_dwordx4 v24, s[12:15], s65 offen nt lds
    buffer_load_dwordx4 v25, s[12:15], s65 offen offset:1024 nt lds
    buffer_load_dwordx4 v26, s[12:15], s65 offen offset:2048 nt lds
    buffer_load_dwordx4 v27, s[12:15], s65 offen offset:3072 nt lds
    s_add_u32 s65, s65, 4096
    s_waitcnt vmcnt(24)
    s_barrier
    s_mov_b32 m0, 81920
    s_nop 0
    buffer_load_dwordx4 v24, s[12:15], s65 offen nt lds
    buffer_load_dwordx4 v25, s[12:15], s65 offen offset:1024 nt lds
    buffer_load_dwordx4 v26, s[12:15], s65 offen offset:2048 nt lds
    buffer_load_dwordx4 v27, s[12:15], s65 offen offset:3072 nt lds
    s_add_u32 s65, s65, 4096
    s_mov_b32 m0, 86016
    s_nop 0
    buffer_load_dwordx4 v24, s[12:15], s65 offen nt lds
    buffer_load_dwordx4 v25, s[12:15], s65 offen offset:1024 nt lds
    buffer_load_dwordx4 v26, s[12:15], s65 offen offset:2048 nt lds
    buffer_load_dwordx4 v27, s[12:15], s65 offen offset:3072 nt lds
    s_add_u32 s65, s65, 4096
    s_waitcnt vmcnt(24)
    s_barrier
    s_mov_b32 m0, 73728
    s_nop 0
    buffer_load_dwordx4 v24, s[12:15], s65 offen nt lds
    buffer_load_dwordx4 v25, s[12:15], s65 offen offset:1024 nt lds
    buffer_load_dwordx4 v26, s[12:15], s65 offen offset:2048 nt lds
    buffer_load_dwordx4 v27, s[12:15], s65 offen offset:3072 nt lds
    s_add_u32 s65, s65, 4096
    s_mov_b32 m0, 77824
    s_nop 0
    buffer_load_dwordx4 v24, s[12:15], s65 offen nt lds
    buffer_load_dwordx4 v25, s[12:15], s65 offen offset:1024 nt lds
    buffer_load_dwordx4 v26, s[12:15], s65 offen offset:2048 nt lds
    buffer_load_dwordx4 v27, s[12:15], s65 offen offset:3072 nt lds
    s_add_u32 s65, s65, 4096
    s_waitcnt vmcnt(24)
    s_barrier
    s_mov_b32 m0, 65536
    s_nop 0
    buffer_load_dwordx4 v24, s[12:15], s65 offen nt lds
    buffer_load_dwordx4 v25, s[12:15], s65 offen offset:1024 nt lds
    buffer_load_dwordx4 v26, s[12:15], s65 offen offset:2048 nt lds
    buffer_load_dwordx4 v27, s[12:15], s65 offen offset:3072 nt lds
    s_add_u32 s65, s65, 4096
    s_mov_b32 m0, 69632
    s_nop 0
    buffer_load_dwordx4 v24, s[12:15], s65 offen nt lds
    buffer_load_dwordx4 v25, s[12:15], s65 offen offset:1024 nt lds
    buffer_load_dwordx4 v26, s[12:15], s65 offen offset:2048 nt lds
    buffer_load_dwordx4 v27, s[12:15], s65 offen offset:3072 nt lds
    s_add_u32 s65, s65, 4096
    s_sub_u32 s64, s64, 1
    s_cmp_lg_u32 s64, 0
    s_cbranch_scc1 L_kld_loop
    s_waitcnt vmcnt(24)
    s_barrier
    s_mov_b32 m0, 106496
    s_nop 0
    buffer_load_dwordx4 v24, s[12:15], s65 offen nt lds
    buffer_load_dwordx4 v25, s[12:15], s65 offen offset:1024 nt lds
    buffer_load_dwordx4 v26, s[12:15], s65 offen offset:2048 nt lds
    buffer_load_dwordx4 v27, s[12:15], s65 offen offset:3072 nt lds
    s_add_u32 s65, s65, 4096
    s_mov_b32 m0, 110592
    s_nop 0
    buffer_load_dwordx4 v24, s[12:15], s65 offen nt lds
    buffer_load_dwordx4 v25, s[12:15], s65 offen offset:1024 nt lds
    buffer_load_dwordx4 v26, s[12:15], s65 offen offset:2048 nt lds
    buffer_load_dwordx4 v27, s[12:15], s65 offen offset:3072 nt lds
    s_add_u32 s65, s65, 4096
    s_waitcnt vmcnt(24)
    s_barrier
    s_mov_b32 m0, 98304
    s_nop 0
    buffer_load_dwordx4 v24, s[12:15], s65 offen nt lds
    buffer_load_dwordx4 v25, s[12:15], s65 offen offset:1024 nt lds
    buffer_load_dwordx4 v26, s[12:15], s65 offen offset:2048 nt lds
    buffer_load_dwordx4 v27, s[12:15], s65 offen offset:3072 nt lds
    s_add_u32 s65, s65, 4096
    s_mov_b32 m0, 102400
    s_nop 0
    buffer_load_dwordx4 v24, s[12:15], s65 offen nt lds
    buffer_load_dwordx4 v25, s[12:15], s65 offen offset:1024 nt lds
    buffer_load_dwordx4 v26, s[12:15], s65 offen offset:2048 nt lds
    buffer_load_dwordx4 v27, s[12:15], s65 offen offset:3072 nt lds
    s_add_u32 s65, s65, 4096
    s_waitcnt vmcnt(24)
    s_barrier
    s_waitcnt vmcnt(16)
    s_barrier
    s_waitcnt vmcnt(8)
    s_barrier
    s_waitcnt vmcnt(0)
    s_barrier
    s_barrier
    s_barrier
    v_xor_b32 v2, 0, v30
    v_xor_b32 v3, 32, v30
    v_xor_b32_e64 v4, 64, v30
    v_xor_b32 v5, 96, v30
    s_mul_i32 s63, s3, 12288
    v_add_u32 v10, s88, v2
    v_add_u32 v11, s88, v3
    v_add_u32 v12, s88, v4
    v_add_u32 v13, s88, v5
    v_add_u32 v16, s89, v2
    v_add_u32 v17, s89, v3
    v_add_u32 v18, s89, v4
    v_add_u32 v19, s89, v5
    v_add_u32 v20, s90, v2
    v_add_u32 v21, s90, v3
    v_add_u32 v22, s90, v4
    v_add_u32 v23, s90, v5
    v_add_u32 v24, s91, v2
    v_add_u32 v25, s91, v3
    v_add_u32 v26, s91, v4
    v_add_u32 v27, s91, v5
    s_add_u32 s60, s31, 0
    s_and_b32 s60, s60, 7
    s_lshl_b32 s60, s60, 6
    v_xor_b32 v14, s60, v29
    s_add_u32 s60, s31, 1
    s_and_b32 s60, s60, 7
    s_lshl_b32 s60, s60, 6
    v_xor_b32 v15, s60, v29
    s_barrier
    s_branch L_p3
L_loader:
    s_sub_u32 s3, s3, 4
    v_lshrrev_b32 v16, 4, v1
    v_and_b32 v17, 15, v1
    s_lshl_b32 s60, s3, 2
    v_add_u32 v18, s60, v16
    v_xor_b32 v18, v18, v17
    v_lshlrev_b32_e64 v18, 4, v18
    v_lshl_add_u32 v2, v16, 10, v18
    s_lshr_b32 s60, s58, 2
    s_add_u32 s60, s60, 0
    s_and_b32 s60, s60, 3
    s_mul_i32 s98, s60, 12288
    s_lshl_b32 s61, s3, 10
    s_add_u32 s98, s98, s61
    s_lshl_b32 s99, s60, 8
    s_lshl_b32 s61, s3, 12
    s_add_u32 s99, s99, s61
    s_waitcnt lgkmcnt(0)
    s_cmp_eq_u32 s57, 1
    s_cselect_b32 s32, s42, s32
    s_cselect_b32 s33, s43, s33
    s_cselect_b32 s38, s48, s38
    s_cselect_b32 s39, s49, s39
    s_mul_i32 s60, s56, 49152
    s_add_u32 s4, s32, s60
    s_addc_u32 s5, s33, 0
    s_and_b32 s5, s5, 0xffff
    s_mov_b32 s6, 49152
    s_mov_b32 s7, 0x20000
    s_add_u32 m0, s98, 114688
    s_add_u32 s60, s99, 0
    buffer_load_dwordx4 v2, s[4:7], s60 offen lds
    s_add_u32 m0, s98, 118784
    s_add_u32 s60, s99, 16384
    buffer_load_dwordx4 v2, s[4:7], s60 offen lds
    s_add_u32 m0, s98, 122880
    s_add_u32 s60, s99, 32768
    buffer_load_dwordx4 v2, s[4:7], s60 offen lds
    v_lshrrev_b32 v18, 3, v1
    v_and_b32 v19, 7, v1
    s_lshl_b32 s60, s3, 7
    v_and_b32 v4, 2, v18
    v_xor_b32 v4, v4, v19
    v_lshlrev_b32_e64 v4, 4, v4
    v_lshl_add_u32 v4, v18, 13, v4
    v_add_u32 v4, s60, v4
    v_and_b32 v5, 2, v18
    v_or_b32 v5, 4, v5
    v_xor_b32 v5, v5, v19
    v_lshlrev_b32_e64 v5, 4, v5
    v_lshl_add_u32 v5, v18, 13, v5
    v_add_u32_e64 v5, s60, v5
    v_add_u32 v5, 64512, v5
    v_and_b32 v6, 2, v18
    v_xor_b32 v6, v6, v19
    v_lshlrev_b32_e64 v6, 4, v6
    v_lshl_add_u32 v6, v18, 13, v6
    v_add_u32_e64 v6, s60, v6
    v_add_u32 v6, 129024, v6
    v_and_b32 v7, 2, v18
    v_or_b32 v7, 4, v7
    v_xor_b32 v7, v7, v19
    v_lshlrev_b32 v7, 4, v7
    v_lshl_add_u32 v7, v18, 13, v7
    v_add_u32_e64 v7, s60, v7
    v_add_u32 v7, 193536, v7
    s_lshl_b32 s59, s3, 14
    s_add_u32 s59, s59, 16384
    s_lshl_b32 s61, s93, 9
    s_add_u32 s8, s38, s61
    s_addc_u32 s9, s39, 0
    s_and_b32 s9, s9, 0xffff
    s_mov_b32 s10, 0
    s_mov_b32 s11, 0x20000
    s_sub_u32 s10, 0x400000, s61
    s_add_u32 s62, s58, 0
    s_and_b32 s62, s62, 15
    s_add_u32 m0, s59, 0
    s_lshl_b32 s62, s62, 18
    buffer_load_dwordx4 v4, s[8:11], s62 offen lds
    buffer_load_dwordx4 v5, s[8:11], s62 offen offset:1024 lds
    buffer_load_dwordx4 v6, s[8:11], s62 offen offset:2048 lds
    buffer_load_dwordx4 v7, s[8:11], s62 offen offset:3072 lds
    s_add_u32 s62, s58, 1
    s_and_b32 s62, s62, 15
    s_add_u32 m0, s59, 4096
    s_lshl_b32 s62, s62, 18
    buffer_load_dwordx4 v4, s[8:11], s62 offen lds
    buffer_load_dwordx4 v5, s[8:11], s62 offen offset:1024 lds
    buffer_load_dwordx4 v6, s[8:11], s62 offen offset:2048 lds
    buffer_load_dwordx4 v7, s[8:11], s62 offen offset:3072 lds
    s_lshr_b32 s60, s58, 2
    s_add_u32 s60, s60, 1
    s_and_b32 s60, s60, 3
    s_mul_i32 s98, s60, 12288
    s_lshl_b32 s61, s3, 10
    s_add_u32 s98, s98, s61
    s_lshl_b32 s99, s60, 8
    s_lshl_b32 s61, s3, 12
    s_add_u32 s99, s99, s61
    s_add_u32 m0, s98, 114688
    s_add_u32 s60, s99, 0
    buffer_load_dwordx4 v2, s[4:7], s60 offen lds
    s_add_u32 m0, s98, 118784
    s_add_u32 s60, s99, 16384
    buffer_load_dwordx4 v2, s[4:7], s60 offen lds
    s_add_u32 m0, s98, 122880
    s_add_u32 s60, s99, 32768
    buffer_load_dwordx4 v2, s[4:7], s60 offen lds
    s_add_u32 s62, s58, 2
    s_and_b32 s62, s62, 15
    s_add_u32 m0, s59, 8192
    s_lshl_b32 s62, s62, 18
    buffer_load_dwordx4 v4, s[8:11], s62 offen lds
    buffer_load_dwordx4 v5, s[8:11], s62 offen offset:1024 lds
    buffer_load_dwordx4 v6, s[8:11], s62 offen offset:2048 lds
    buffer_load_dwordx4 v7, s[8:11], s62 offen offset:3072 lds
    s_cmp_eq_u32 s57, 1
    s_cselect_b32 s34, s44, s34
    s_cselect_b32 s35, s45, s35
    s_cselect_b32 s36, s46, s36
    s_cselect_b32 s37, s47, s37
    s_cselect_b32 s40, s50, s40
    s_cselect_b32 s41, s51, s41
    s_lshl_b32 s60, s56, 3
    s_add_u32 s60, s60, s54
    s_lshl_b32 s60, s60, 18
    s_add_u32 s12, s34, s60
    s_addc_u32 s13, s35, 0
    s_and_b32 s13, s13, 0xffff
    s_mov_b32 s14, 262144
    s_mov_b32 s15, 0x20000
    s_add_u32 s16, s36, s60
    s_addc_u32 s17, s37, 0
    s_and_b32 s17, s17, 0xffff
    s_mov_b32 s18, 262144
    s_mov_b32 s19, 0x20000
    s_lshl_b32 s61, s93, 18
    s_add_u32 s20, s40, s61
    s_addc_u32 s21, s41, 0
    s_and_b32 s21, s21, 0xffff
    s_mov_b32 s22, 262144
    s_mov_b32 s23, 0x20000
    s_lshl_b32 s28, s3, 11
    v_lshlrev_b32 v18, 8, v16
    v_add_u32 v18, s28, v18
    s_lshl_b32 s61, s3, 3
    s_and_b32 s61, s61, 15
    v_add_u32 v8, s61, v16
    v_xor_b32 v8, v8, v17
    v_lshl_add_u32 v8, v8, 4, v18
    v_add_u32 v9, s61, v16
    v_add_u32 v9, 4, v9
    v_xor_b32_e64 v9, v9, v17
    v_lshl_add_u32 v9, v9, 4, v18
    v_lshlrev_b32 v10, 2, v16
    v_xor_b32 v10, v10, v17
    v_lshl_add_u32 v10, v10, 4, v18
    v_lshrrev_b32 v18, 3, v1
    v_and_b32 v19, 7, v1
    s_lshl_b32 s60, s3, 8
    v_and_b32 v12, 2, v18
    v_xor_b32 v12, v12, v19
    v_lshlrev_b32 v12, 4, v12
    v_lshl_add_u32 v12, v18, 10, v12
    v_add_u32 v12, s60, v12
    v_and_b32 v13, 2, v18
    v_or_b32 v13, 4, v13
    v_xor_b32 v13, v13, v19
    v_lshlrev_b32_e64 v13, 4, v13
    v_lshl_add_u32 v13, v18, 10, v13
    v_add_u32_e64 v13, s60, v13
    v_add_u32 v13, 7168, v13
    v_and_b32 v14, 2, v18
    v_xor_b32 v14, v14, v19
    v_lshlrev_b32_e64 v14, 4, v14
    v_lshl_add_u32 v14, v18, 10, v14
    v_add_u32_e64 v14, s60, v14
    v_add_u32 v14, 14336, v14
    v_and_b32 v15, 2, v18
    v_or_b32 v15, 4, v15
    v_xor_b32 v15, v15, v19
    v_lshlrev_b32 v15, 4, v15
    v_lshl_add_u32 v15, v18, 10, v15
    v_add_u32_e64 v15, s60, v15
    v_add_u32 v15, 21504, v15
    s_mov_b32 s88, 49152
    s_cmp_eq_u32 s3, 1
    s_cselect_b32 s88, 57344, s88
    s_cmp_eq_u32 s3, 2
    s_cselect_b32 s88, 114688, s88
    s_cmp_eq_u32 s3, 3
    s_cselect_b32 s88, 122880, s88
    s_mov_b32 s89, 131072
    s_cmp_eq_u32 s3, 1
    s_cselect_b32 s89, 90112, s89
    s_cmp_eq_u32 s3, 2
    s_cselect_b32 s89, 81920, s89
    s_cmp_eq_u32 s3, 3
    s_cselect_b32 s89, 73728, s89
    s_mov_b32 s90, 16384
    s_cmp_eq_u32 s3, 1
    s_cselect_b32 s90, 65536, s90
    s_cmp_eq_u32 s3, 2
    s_cselect_b32 s90, 24576, s90
    s_cmp_eq_u32 s3, 3
    s_cselect_b32 s90, 106496, s90
    s_mov_b32 s91, 32768
    s_cmp_eq_u32 s3, 1
    s_cselect_b32 s91, 98304, s91
    s_cmp_eq_u32 s3, 2
    s_cselect_b32 s91, 40960, s91
    s_cmp_eq_u32 s3, 3
    s_cselect_b32 s91, 0, s91
    s_mov_b32 s65, 0
    s_mov_b32 s66, 0
    s_waitcnt vmcnt(7)
    s_barrier
    s_add_u32 s62, s58, 3
    s_and_b32 s62, s62, 15
    s_add_u32 m0, s59, 12288
    s_lshl_b32 s62, s62, 18
    buffer_load_dwordx4 v4, s[8:11], s62 offen lds
    buffer_load_dwordx4 v5, s[8:11], s62 offen offset:1024 lds
    buffer_load_dwordx4 v6, s[8:11], s62 offen offset:2048 lds
    buffer_load_dwordx4 v7, s[8:11], s62 offen offset:3072 lds
    s_lshr_b32 s60, s58, 2
    s_add_u32 s60, s60, 2
    s_and_b32 s60, s60, 3
    s_mul_i32 s98, s60, 12288
    s_lshl_b32 s61, s3, 10
    s_add_u32 s98, s98, s61
    s_lshl_b32 s99, s60, 8
    s_lshl_b32 s61, s3, 12
    s_add_u32 s99, s99, s61
    s_add_u32 m0, s98, 114688
    s_add_u32 s60, s99, 0
    buffer_load_dwordx4 v2, s[4:7], s60 offen lds
    s_add_u32 m0, s98, 118784
    s_add_u32 s60, s99, 16384
    buffer_load_dwordx4 v2, s[4:7], s60 offen lds
    s_add_u32 m0, s98, 122880
    s_add_u32 s60, s99, 32768
    buffer_load_dwordx4 v2, s[4:7], s60 offen lds
    s_waitcnt vmcnt(7)
    s_barrier
    s_add_u32 s62, s58, 4
    s_and_b32 s62, s62, 15
    s_add_u32 m0, s59, 0
    s_lshl_b32 s62, s62, 18
    buffer_load_dwordx4 v4, s[8:11], s62 offen lds
    buffer_load_dwordx4 v5, s[8:11], s62 offen offset:1024 lds
    buffer_load_dwordx4 v6, s[8:11], s62 offen offset:2048 lds
    buffer_load_dwordx4 v7, s[8:11], s62 offen offset:3072 lds
    s_waitcnt vmcnt(7)
    s_barrier
    s_add_u32 s62, s58, 5
    s_and_b32 s62, s62, 15
    s_add_u32 m0, s59, 4096
    s_lshl_b32 s62, s62, 18
    buffer_load_dwordx4 v4, s[8:11], s62 offen lds
    buffer_load_dwordx4 v5, s[8:11], s62 offen offset:1024 lds
    buffer_load_dwordx4 v6, s[8:11], s62 offen offset:2048 lds
    buffer_load_dwordx4 v7, s[8:11], s62 offen offset:3072 lds
    s_waitcnt vmcnt(4)
    s_barrier
    s_add_u32 s62, s58, 6
    s_and_b32 s62, s62, 15
    s_add_u32 m0, s59, 8192
    s_lshl_b32 s62, s62, 18
    buffer_load_dwordx4 v4, s[8:11], s62 offen lds
    buffer_load_dwordx4 v5, s[8:11], s62 offen offset:1024 lds
    buffer_load_dwordx4 v6, s[8:11], s62 offen offset:2048 lds
    buffer_load_dwordx4 v7, s[8:11], s62 offen offset:3072 lds
    s_lshr_b32 s60, s58, 2
    s_add_u32 s60, s60, 3
    s_and_b32 s60, s60, 3
    s_mul_i32 s98, s60, 12288
    s_lshl_b32 s61, s3, 10
    s_add_u32 s98, s98, s61
    s_lshl_b32 s99, s60, 8
    s_lshl_b32 s61, s3, 12
    s_add_u32 s99, s99, s61
    s_add_u32 m0, s98, 114688
    s_add_u32 s60, s99, 0
    buffer_load_dwordx4 v2, s[4:7], s60 offen lds
    s_add_u32 m0, s98, 118784
    s_add_u32 s60, s99, 16384
    buffer_load_dwordx4 v2, s[4:7], s60 offen lds
    s_add_u32 m0, s98, 122880
    s_add_u32 s60, s99, 32768
    buffer_load_dwordx4 v2, s[4:7], s60 offen lds
    s_waitcnt vmcnt(7)
    s_barrier
    s_add_u32 s62, s58, 7
    s_and_b32 s62, s62, 15
    s_add_u32 m0, s59, 12288
    s_lshl_b32 s62, s62, 18
    buffer_load_dwordx4 v4, s[8:11], s62 offen lds
    buffer_load_dwordx4 v5, s[8:11], s62 offen offset:1024 lds
    buffer_load_dwordx4 v6, s[8:11], s62 offen offset:2048 lds
    buffer_load_dwordx4 v7, s[8:11], s62 offen offset:3072 lds
    s_waitcnt vmcnt(7)
    s_barrier
    s_add_u32 s62, s58, 8
    s_and_b32 s62, s62, 15
    s_add_u32 m0, s59, 0
    s_lshl_b32 s62, s62, 18
    buffer_load_dwordx4 v4, s[8:11], s62 offen lds
    buffer_load_dwordx4 v5, s[8:11], s62 offen offset:1024 lds
    buffer_load_dwordx4 v6, s[8:11], s62 offen offset:2048 lds
    buffer_load_dwordx4 v7, s[8:11], s62 offen offset:3072 lds
    s_waitcnt vmcnt(4)
    s_barrier
    s_add_u32 s62, s58, 9
    s_and_b32 s62, s62, 15
    s_add_u32 m0, s59, 4096
    s_lshl_b32 s62, s62, 18
    buffer_load_dwordx4 v4, s[8:11], s62 offen lds
    buffer_load_dwordx4 v5, s[8:11], s62 offen offset:1024 lds
    buffer_load_dwordx4 v6, s[8:11], s62 offen offset:2048 lds
    buffer_load_dwordx4 v7, s[8:11], s62 offen offset:3072 lds
    s_waitcnt vmcnt(4)
    s_barrier
    s_add_u32 s62, s58, 10
    s_and_b32 s62, s62, 15
    s_add_u32 m0, s59, 8192
    s_lshl_b32 s62, s62, 18
    buffer_load_dwordx4 v4, s[8:11], s62 offen lds
    buffer_load_dwordx4 v5, s[8:11], s62 offen offset:1024 lds
    buffer_load_dwordx4 v6, s[8:11], s62 offen offset:2048 lds
    buffer_load_dwordx4 v7, s[8:11], s62 offen offset:3072 lds
    s_waitcnt vmcnt(4)
    s_barrier
    s_add_u32 s62, s58, 11
    s_and_b32 s62, s62, 15
    s_add_u32 m0, s59, 12288
    s_lshl_b32 s62, s62, 18
    buffer_load_dwordx4 v4, s[8:11], s62 offen lds
    buffer_load_dwordx4 v5, s[8:11], s62 offen offset:1024 lds
    buffer_load_dwordx4 v6, s[8:11], s62 offen offset:2048 lds
    buffer_load_dwordx4 v7, s[8:11], s62 offen offset:3072 lds
    s_waitcnt vmcnt(4)
    s_barrier
    s_add_u32 s62, s58, 12
    s_and_b32 s62, s62, 15
    s_add_u32 m0, s59, 0
    s_lshl_b32 s62, s62, 18
    buffer_load_dwordx4 v4, s[8:11], s62 offen lds
    buffer_load_dwordx4 v5, s[8:11], s62 offen offset:1024 lds
    buffer_load_dwordx4 v6, s[8:11], s62 offen offset:2048 lds
    buffer_load_dwordx4 v7, s[8:11], s62 offen offset:3072 lds
    s_waitcnt vmcnt(4)
    s_barrier
    s_add_u32 s62, s58, 13
    s_and_b32 s62, s62, 15
    s_add_u32 m0, s59, 4096
    s_lshl_b32 s62, s62, 18
    buffer_load_dwordx4 v4, s[8:11], s62 offen lds
    buffer_load_dwordx4 v5, s[8:11], s62 offen offset:1024 lds
    buffer_load_dwordx4 v6, s[8:11], s62 offen offset:2048 lds
    buffer_load_dwordx4 v7, s[8:11], s62 offen offset:3072 lds
    s_waitcnt vmcnt(4)
    s_barrier
    s_add_u32 s62, s58, 14
    s_and_b32 s62, s62, 15
    s_add_u32 m0, s59, 8192
    s_lshl_b32 s62, s62, 18
    buffer_load_dwordx4 v4, s[8:11], s62 offen lds
    buffer_load_dwordx4 v5, s[8:11], s62 offen offset:1024 lds
    buffer_load_dwordx4 v6, s[8:11], s62 offen offset:2048 lds
    buffer_load_dwordx4 v7, s[8:11], s62 offen offset:3072 lds
    s_waitcnt vmcnt(4)
    s_barrier
    s_add_u32 s62, s58, 15
    s_and_b32 s62, s62, 15
    s_add_u32 m0, s59, 12288
    s_lshl_b32 s62, s62, 18
    buffer_load_dwordx4 v4, s[8:11], s62 offen lds
    buffer_load_dwordx4 v5, s[8:11], s62 offen offset:1024 lds
    buffer_load_dwordx4 v6, s[8:11], s62 offen offset:2048 lds
    buffer_load_dwordx4 v7, s[8:11], s62 offen offset:3072 lds
    s_waitcnt vmcnt(4)
    s_barrier
    s_add_u32 m0, s28, 106496
    s_nop 0
    buffer_load_dwordx4 v8, s[12:15], s65 offen nt lds
    buffer_load_dwordx4 v9, s[12:15], s65 offen offset:1024 nt lds
    s_add_u32 s65, s65, 8192
    s_add_u32 m0, s28, 98304
    s_nop 0
    buffer_load_dwordx4 v8, s[12:15], s65 offen nt lds
    buffer_load_dwordx4 v9, s[12:15], s65 offen offset:1024 nt lds
    s_add_u32 s65, s65, 8192
    s_waitcnt vmcnt(4)
    s_barrier
    s_add_u32 m0, s28, 0
    s_nop 0
    buffer_load_dwordx4 v10, s[16:19], s66 offen nt lds
    buffer_load_dwordx4 v10, s[16:19], s66 offen offset:1024 nt lds
    s_add_u32 s66, s66, 8192
    s_add_u32 m0, s28, 90112
    s_nop 0
    buffer_load_dwordx4 v8, s[12:15], s65 offen nt lds
    buffer_load_dwordx4 v9, s[12:15], s65 offen offset:1024 nt lds
    s_add_u32 s65, s65, 8192
    s_barrier
    s_add_u32 m0, s28, 8192
    s_nop 0
    buffer_load_dwordx4 v10, s[16:19], s66 offen nt lds
    buffer_load_dwordx4 v10, s[16:19], s66 offen offset:1024 nt lds
    s_add_u32 s66, s66, 8192
    s_add_u32 m0, s28, 81920
    s_nop 0
    buffer_load_dwordx4 v8, s[12:15], s65 offen nt lds
    buffer_load_dwordx4 v9, s[12:15], s65 offen offset:1024 nt lds
    s_add_u32 s65, s65, 8192
    s_barrier
    s_waitcnt vmcnt(8)
    s_barrier
    s_cmp_eq_u32 s3, 3
    s_cbranch_scc1 L_vloader
    s_waitcnt vmcnt(4)
    s_barrier
    s_waitcnt vmcnt(0)
    s_barrier
    s_mov_b32 s32, s94
    s_and_b32 s33, s95, 0xffff
    s_mov_b32 s34, 256
    s_mov_b32 s35, 0x20000
    s_mov_b32 s36, s52
    s_and_b32 s37, s53, 0xffff
    s_mov_b32 s38, 14811136
    s_mov_b32 s39, 0x20000
    s_lshl_b32 s60, s92, 13
    s_add_u32 s60, s60, 14680064
    v_lshlrev_b32 v20, 7, v1
    v_add_u32 v20, s60, v20
    s_lshl_b32 s60, s92, 2
    v_mov_b32 v22, s60
    s_or_b32 s29, s3, s93
    s_cmp_lg_u32 s29, 0
    s_cbranch_scc1 L_fl1
    v_mov_b32_e64 v21, 0
    buffer_store_dword v21, v20, s[36:39], 0 offen sc1
L_fl1:
    s_mov_b32 s64, 8
L_ld_idle1:
    s_barrier
    s_sub_u32 s64, s64, 1
    s_cmp_lg_u32 s64, 0
    s_cbranch_scc1 L_ld_idle1
    s_cmp_lg_u32 s29, 0
    s_cbranch_scc1 L_fl2
    s_waitcnt vmcnt(0)
    v_mov_b32 v21, 1
    s_mov_b64 exec, 1
    buffer_store_dword v21, v22, s[32:35], 0 offen sc1
    s_mov_b64 exec, -1
L_fl2:
    s_mov_b32 s64, 10
L_ld_idle2:
    s_barrier
    s_sub_u32 s64, s64, 1
    s_cmp_lg_u32 s64, 0
    s_cbranch_scc1 L_ld_idle2
    s_cmp_lg_u32 s3, 0
    s_cbranch_scc1 L_fl3
    buffer_load_dword v23, v22, s[32:35], 0 offen sc1
L_fl3:
    s_mov_b32 s64, 8
L_ld_idle3:
    s_barrier
    s_sub_u32 s64, s64, 1
    s_cmp_lg_u32 s64, 0
    s_cbranch_scc1 L_ld_idle3
    s_waitcnt vmcnt(0)
    s_add_u32 m0, s88, 0
    s_add_u32 s62, s31, 0
    s_and_b32 s62, s62, 7
    s_lshl_b32 s62, s62, 15
    buffer_load_dwordx4 v12, s[20:23], s62 offen lds
    buffer_load_dwordx4 v13, s[20:23], s62 offen offset:1024 lds
    buffer_load_dwordx4 v14, s[20:23], s62 offen offset:2048 lds
    buffer_load_dwordx4 v15, s[20:23], s62 offen offset:3072 lds
    s_add_u32 m0, s88, 4096
    s_add_u32 s62, s31, 1
    s_and_b32 s62, s62, 7
    s_lshl_b32 s62, s62, 15
    buffer_load_dwordx4 v12, s[20:23], s62 offen lds
    buffer_load_dwordx4 v13, s[20:23], s62 offen offset:1024 lds
    buffer_load_dwordx4 v14, s[20:23], s62 offen offset:2048 lds
    buffer_load_dwordx4 v15, s[20:23], s62 offen offset:3072 lds
    s_barrier
    s_add_u32 m0, s89, 0
    s_add_u32 s62, s31, 2
    s_and_b32 s62, s62, 7
    s_lshl_b32 s62, s62, 15
    buffer_load_dwordx4 v12, s[20:23], s62 offen lds
    buffer_load_dwordx4 v13, s[20:23], s62 offen offset:1024 lds
    buffer_load_dwordx4 v14, s[20:23], s62 offen offset:2048 lds
    buffer_load_dwordx4 v15, s[20:23], s62 offen offset:3072 lds
    s_add_u32 m0, s89, 4096
    s_add_u32 s62, s31, 3
    s_and_b32 s62, s62, 7
    s_lshl_b32 s62, s62, 15
    buffer_load_dwordx4 v12, s[20:23], s62 offen lds
    buffer_load_dwordx4 v13, s[20:23], s62 offen offset:1024 lds
    buffer_load_dwordx4 v14, s[20:23], s62 offen offset:2048 lds
    buffer_load_dwordx4 v15, s[20:23], s62 offen offset:3072 lds
    s_barrier
    s_barrier
    s_add_u32 m0, s90, 0
    s_add_u32 s62, s31, 4
    s_and_b32 s62, s62, 7
    s_lshl_b32 s62, s62, 15
    buffer_load_dwordx4 v12, s[20:23], s62 offen lds
    buffer_load_dwordx4 v13, s[20:23], s62 offen offset:1024 lds
    buffer_load_dwordx4 v14, s[20:23], s62 offen offset:2048 lds
    buffer_load_dwordx4 v15, s[20:23], s62 offen offset:3072 lds
    s_add_u32 m0, s90, 4096
    s_add_u32 s62, s31, 5
    s_and_b32 s62, s62, 7
    s_lshl_b32 s62, s62, 15
    buffer_load_dwordx4 v12, s[20:23], s62 offen lds
    buffer_load_dwordx4 v13, s[20:23], s62 offen offset:1024 lds
    buffer_load_dwordx4 v14, s[20:23], s62 offen offset:2048 lds
    buffer_load_dwordx4 v15, s[20:23], s62 offen offset:3072 lds
    s_barrier
    s_barrier
    s_add_u32 m0, s91, 0
    s_add_u32 s62, s31, 6
    s_and_b32 s62, s62, 7
    s_lshl_b32 s62, s62, 15
    buffer_load_dwordx4 v12, s[20:23], s62 offen lds
    buffer_load_dwordx4 v13, s[20:23], s62 offen offset:1024 lds
    buffer_load_dwordx4 v14, s[20:23], s62 offen offset:2048 lds
    buffer_load_dwordx4 v15, s[20:23], s62 offen offset:3072 lds
    s_add_u32 m0, s91, 4096
    s_add_u32 s62, s31, 7
    s_and_b32 s62, s62, 7
    s_lshl_b32 s62, s62, 15
    buffer_load_dwordx4 v12, s[20:23], s62 offen lds
    buffer_load_dwordx4 v13, s[20:23], s62 offen offset:1024 lds
    buffer_load_dwordx4 v14, s[20:23], s62 offen offset:2048 lds
    buffer_load_dwordx4 v15, s[20:23], s62 offen offset:3072 lds
    v_lshlrev_b32_e64 v19, 4, v1
    s_waitcnt vmcnt(16)
    s_barrier
    s_barrier
    s_add_u32 m0, s88, 0
    s_add_u32 s62, s31, 0
    s_and_b32 s62, s62, 7
    s_lshl_b32 s62, s62, 15
    s_add_u32 s62, s62, 128
    buffer_load_dwordx4 v12, s[20:23], s62 offen lds
    buffer_load_dwordx4 v13, s[20:23], s62 offen offset:1024 lds
    buffer_load_dwordx4 v14, s[20:23], s62 offen offset:2048 lds
    buffer_load_dwordx4 v15, s[20:23], s62 offen offset:3072 lds
    s_barrier
    s_add_u32 m0, s88, 4096
    s_add_u32 s62, s31, 1
    s_and_b32 s62, s62, 7
    s_lshl_b32 s62, s62, 15
    s_add_u32 s62, s62, 128
    buffer_load_dwordx4 v12, s[20:23], s62 offen lds
    buffer_load_dwordx4 v13, s[20:23], s62 offen offset:1024 lds
    buffer_load_dwordx4 v14, s[20:23], s62 offen offset:2048 lds
    buffer_load_dwordx4 v15, s[20:23], s62 offen offset:3072 lds
    s_waitcnt vmcnt(16)
    s_barrier
    s_add_u32 m0, s89, 0
    s_add_u32 s62, s31, 2
    s_and_b32 s62, s62, 7
    s_lshl_b32 s62, s62, 15
    s_add_u32 s62, s62, 128
    buffer_load_dwordx4 v12, s[20:23], s62 offen lds
    buffer_load_dwordx4 v13, s[20:23], s62 offen offset:1024 lds
    buffer_load_dwordx4 v14, s[20:23], s62 offen offset:2048 lds
    buffer_load_dwordx4 v15, s[20:23], s62 offen offset:3072 lds
    s_barrier
    s_add_u32 m0, s89, 4096
    s_add_u32 s62, s31, 3
    s_and_b32 s62, s62, 7
    s_lshl_b32 s62, s62, 15
    s_add_u32 s62, s62, 128
    buffer_load_dwordx4 v12, s[20:23], s62 offen lds
    buffer_load_dwordx4 v13, s[20:23], s62 offen offset:1024 lds
    buffer_load_dwordx4 v14, s[20:23], s62 offen offset:2048 lds
    buffer_load_dwordx4 v15, s[20:23], s62 offen offset:3072 lds
    s_waitcnt vmcnt(16)
    s_barrier
    s_add_u32 m0, s90, 0
    s_add_u32 s62, s31, 4
    s_and_b32 s62, s62, 7
    s_lshl_b32 s62, s62, 15
    s_add_u32 s62, s62, 128
    buffer_load_dwordx4 v12, s[20:23], s62 offen lds
    buffer_load_dwordx4 v13, s[20:23], s62 offen offset:1024 lds
    buffer_load_dwordx4 v14, s[20:23], s62 offen offset:2048 lds
    buffer_load_dwordx4 v15, s[20:23], s62 offen offset:3072 lds
    s_barrier
    s_add_u32 m0, s90, 4096
    s_add_u32 s62, s31, 5
    s_and_b32 s62, s62, 7
    s_lshl_b32 s62, s62, 15
    s_add_u32 s62, s62, 128
    buffer_load_dwordx4 v12, s[20:23], s62 offen lds
    buffer_load_dwordx4 v13, s[20:23], s62 offen offset:1024 lds
    buffer_load_dwordx4 v14, s[20:23], s62 offen offset:2048 lds
    buffer_load_dwordx4 v15, s[20:23], s62 offen offset:3072 lds
    s_waitcnt vmcnt(20)
    s_barrier
    s_add_u32 m0, s91, 0
    s_add_u32 s62, s31, 6
    s_and_b32 s62, s62, 7
    s_lshl_b32 s62, s62, 15
    s_add_u32 s62, s62, 128
    buffer_load_dwordx4 v12, s[20:23], s62 offen lds
    buffer_load_dwordx4 v13, s[20:23], s62 offen offset:1024 lds
    buffer_load_dwordx4 v14, s[20:23], s62 offen offset:2048 lds
    buffer_load_dwordx4 v15, s[20:23], s62 offen offset:3072 lds
    s_waitcnt vmcnt(20)
    s_barrier
    s_add_u32 m0, s91, 4096
    s_add_u32 s62, s31, 7
    s_and_b32 s62, s62, 7
    s_lshl_b32 s62, s62, 15
    s_add_u32 s62, s62, 128
    buffer_load_dwordx4 v12, s[20:23], s62 offen lds
    buffer_load_dwordx4 v13, s[20:23], s62 offen offset:1024 lds
    buffer_load_dwordx4 v14, s[20:23], s62 offen offset:2048 lds
    buffer_load_dwordx4 v15, s[20:23], s62 offen offset:3072 lds
    s_waitcnt vmcnt(20)
    s_barrier
    s_waitcnt vmcnt(16)
    s_barrier
    s_waitcnt vmcnt(12)
    s_barrier
    s_waitcnt vmcnt(8)
    s_barrier
    s_waitcnt vmcnt(4)
    s_barrier
    s_waitcnt vmcnt(0)
    s_barrier
    s_cmp_lg_u32 s3, 0
    s_cbranch_scc1 L_rdy_done
    s_mov_b32 s64, 0
L_rdy:
    v_readfirstlane_b32 s61, v23
    s_add_u32 s64, s64, 1
    s_cmp_lg_u32 s61, 0
    s_cbranch_scc1 L_rdy_done
    s_cmp_ge_u32 s64, 0x40000
    s_cbranch_scc1 L_rdy_done
    buffer_load_dword v23, v22, s[32:35], 0 offen sc1
    s_waitcnt vmcnt(0)
    s_branch L_rdy
L_rdy_done:
    s_barrier
    s_branch L_ld_end
L_vloader:
    v_lshrrev_b32 v60, 4, v1
    v_and_b32 v61, 15, v1
    v_lshlrev_b32 v24, 2, v60
    v_xor_b32 v24, v24, v61
    v_lshlrev_b32 v24, 4, v24
    v_lshl_add_u32 v24, v60, 8, v24
    s_mov_b32 s66, 16384
    s_mov_b32 m0, 16384
    s_nop 0
    buffer_load_dwordx4 v24, s[16:19], s66 offen nt lds
    buffer_load_dwordx4 v24, s[16:19], s66 offen offset:1024 nt lds
    buffer_load_dwordx4 v24, s[16:19], s66 offen offset:2048 nt lds
    buffer_load_dwordx4 v24, s[16:19], s66 offen offset:3072 nt lds
    s_add_u32 s66, s66, 4096
    s_mov_b32 m0, 20480
    s_nop 0
    buffer_load_dwordx4 v24, s[16:19], s66 offen nt lds
    buffer_load_dwordx4 v24, s[16:19], s66 offen offset:1024 nt lds
    buffer_load_dwordx4 v24, s[16:19], s66 offen offset:2048 nt lds
    buffer_load_dwordx4 v24, s[16:19], s66 offen offset:3072 nt lds
    s_add_u32 s66, s66, 4096
    s_mov_b32 m0, 24576
    s_nop 0
    buffer_load_dwordx4 v24, s[16:19], s66 offen nt lds
    buffer_load_dwordx4 v24, s[16:19], s66 offen offset:1024 nt lds
    buffer_load_dwordx4 v24, s[16:19], s66 offen offset:2048 nt lds
    buffer_load_dwordx4 v24, s[16:19], s66 offen offset:3072 nt lds
    s_add_u32 s66, s66, 4096
    s_mov_b32 m0, 28672
    s_nop 0
    buffer_load_dwordx4 v24, s[16:19], s66 offen nt lds
    buffer_load_dwordx4 v24, s[16:19], s66 offen offset:1024 nt lds
    buffer_load_dwordx4 v24, s[16:19], s66 offen offset:2048 nt lds
    buffer_load_dwordx4 v24, s[16:19], s66 offen offset:3072 nt lds
    s_add_u32 s66, s66, 4096
    s_waitcnt vmcnt(20)
    s_mov_b32 s64, 4
L_vld_loop:
    s_waitcnt vmcnt(24)
    s_barrier
    s_mov_b32 m0, 32768
    s_nop 0
    buffer_load_dwordx4 v24, s[16:19], s66 offen nt lds
    buffer_load_dwordx4 v24, s[16:19], s66 offen offset:1024 nt lds
    buffer_load_dwordx4 v24, s[16:19], s66 offen offset:2048 nt lds
    buffer_load_dwordx4 v24, s[16:19], s66 offen offset:3072 nt lds
    s_add_u32 s66, s66, 4096
    s_mov_b32 m0, 36864
    s_nop 0
    buffer_load_dwordx4 v24, s[16:19], s66 offen nt lds
    buffer_load_dwordx4 v24, s[16:19], s66 offen offset:1024 nt lds
    buffer_load_dwordx4 v24, s[16:19], s66 offen offset:2048 nt lds
    buffer_load_dwordx4 v24, s[16:19], s66 offen offset:3072 nt lds
    s_add_u32 s66, s66, 4096
    s_waitcnt vmcnt(24)
    s_barrier
    s_mov_b32 m0, 40960
    s_nop 0
    buffer_load_dwordx4 v24, s[16:19], s66 offen nt lds
    buffer_load_dwordx4 v24, s[16:19], s66 offen offset:1024 nt lds
    buffer_load_dwordx4 v24, s[16:19], s66 offen offset:2048 nt lds
    buffer_load_dwordx4 v24, s[16:19], s66 offen offset:3072 nt lds
    s_add_u32 s66, s66, 4096
    s_mov_b32 m0, 45056
    s_nop 0
    buffer_load_dwordx4 v24, s[16:19], s66 offen nt lds
    buffer_load_dwordx4 v24, s[16:19], s66 offen offset:1024 nt lds
    buffer_load_dwordx4 v24, s[16:19], s66 offen offset:2048 nt lds
    buffer_load_dwordx4 v24, s[16:19], s66 offen offset:3072 nt lds
    s_add_u32 s66, s66, 4096
    s_waitcnt vmcnt(24)
    s_barrier
    s_mov_b32 m0, 0
    s_nop 0
    buffer_load_dwordx4 v24, s[16:19], s66 offen nt lds
    buffer_load_dwordx4 v24, s[16:19], s66 offen offset:1024 nt lds
    buffer_load_dwordx4 v24, s[16:19], s66 offen offset:2048 nt lds
    buffer_load_dwordx4 v24, s[16:19], s66 offen offset:3072 nt lds
    s_add_u32 s66, s66, 4096
    s_mov_b32 m0, 4096
    s_nop 0
    buffer_load_dwordx4 v24, s[16:19], s66 offen nt lds
    buffer_load_dwordx4 v24, s[16:19], s66 offen offset:1024 nt lds
    buffer_load_dwordx4 v24, s[16:19], s66 offen offset:2048 nt lds
    buffer_load_dwordx4 v24, s[16:19], s66 offen offset:3072 nt lds
    s_add_u32 s66, s66, 4096
    s_waitcnt vmcnt(24)
    s_barrier
    s_mov_b32 m0, 8192
    s_nop 0
    buffer_load_dwordx4 v24, s[16:19], s66 offen nt lds
    buffer_load_dwordx4 v24, s[16:19], s66 offen offset:1024 nt lds
    buffer_load_dwordx4 v24, s[16:19], s66 offen offset:2048 nt lds
    buffer_load_dwordx4 v24, s[16:19], s66 offen offset:3072 nt lds
    s_add_u32 s66, s66, 4096
    s_mov_b32 m0, 12288
    s_nop 0
    buffer_load_dwordx4 v24, s[16:19], s66 offen nt lds
    buffer_load_dwordx4 v24, s[16:19], s66 offen offset:1024 nt lds
    buffer_load_dwordx4 v24, s[16:19], s66 offen offset:2048 nt lds
    buffer_load_dwordx4 v24, s[16:19], s66 offen offset:3072 nt lds
    s_add_u32 s66, s66, 4096
    s_waitcnt vmcnt(24)
    s_barrier
    s_mov_b32 m0, 16384
    s_nop 0
    buffer_load_dwordx4 v24, s[16:19], s66 offen nt lds
    buffer_load_dwordx4 v24, s[16:19], s66 offen offset:1024 nt lds
    buffer_load_dwordx4 v24, s[16:19], s66 offen offset:2048 nt lds
    buffer_load_dwordx4 v24, s[16:19], s66 offen offset:3072 nt lds
    s_add_u32 s66, s66, 4096
    s_mov_b32 m0, 20480
    s_nop 0
    buffer_load_dwordx4 v24, s[16:19], s66 offen nt lds
    buffer_load_dwordx4 v24, s[16:19], s66 offen offset:1024 nt lds
    buffer_load_dwordx4 v24, s[16:19], s66 offen offset:2048 nt lds
    buffer_load_dwordx4 v24, s[16:19], s66 offen offset:3072 nt lds
    s_add_u32 s66, s66, 4096
    s_waitcnt vmcnt(24)
    s_barrier
    s_mov_b32 m0, 24576
    s_nop 0
    buffer_load_dwordx4 v24, s[16:19], s66 offen nt lds
    buffer_load_dwordx4 v24, s[16:19], s66 offen offset:1024 nt lds
    buffer_load_dwordx4 v24, s[16:19], s66 offen offset:2048 nt lds
    buffer_load_dwordx4 v24, s[16:19], s66 offen offset:3072 nt lds
    s_add_u32 s66, s66, 4096
    s_mov_b32 m0, 28672
    s_nop 0
    buffer_load_dwordx4 v24, s[16:19], s66 offen nt lds
    buffer_load_dwordx4 v24, s[16:19], s66 offen offset:1024 nt lds
    buffer_load_dwordx4 v24, s[16:19], s66 offen offset:2048 nt lds
    buffer_load_dwordx4 v24, s[16:19], s66 offen offset:3072 nt lds
    s_add_u32 s66, s66, 4096
    s_sub_u32 s64, s64, 1
    s_cmp_lg_u32 s64, 0
    s_cbranch_scc1 L_vld_loop
    s_waitcnt vmcnt(24)
    s_barrier
    s_mov_b32 m0, 32768
    s_nop 0
    buffer_load_dwordx4 v24, s[16:19], s66 offen nt lds
    buffer_load_dwordx4 v24, s[16:19], s66 offen offset:1024 nt lds
    buffer_load_dwordx4 v24, s[16:19], s66 offen offset:2048 nt lds
    buffer_load_dwordx4 v24, s[16:19], s66 offen offset:3072 nt lds
    s_add_u32 s66, s66, 4096
    s_mov_b32 m0, 36864
    s_nop 0
    buffer_load_dwordx4 v24, s[16:19], s66 offen nt lds
    buffer_load_dwordx4 v24, s[16:19], s66 offen offset:1024 nt lds
    buffer_load_dwordx4 v24, s[16:19], s66 offen offset:2048 nt lds
    buffer_load_dwordx4 v24, s[16:19], s66 offen offset:3072 nt lds
    s_add_u32 s66, s66, 4096
    s_waitcnt vmcnt(24)
    s_barrier
    s_mov_b32 m0, 40960
    s_nop 0
    buffer_load_dwordx4 v24, s[16:19], s66 offen nt lds
    buffer_load_dwordx4 v24, s[16:19], s66 offen offset:1024 nt lds
    buffer_load_dwordx4 v24, s[16:19], s66 offen offset:2048 nt lds
    buffer_load_dwordx4 v24, s[16:19], s66 offen offset:3072 nt lds
    s_add_u32 s66, s66, 4096
    s_mov_b32 m0, 45056
    s_nop 0
    buffer_load_dwordx4 v24, s[16:19], s66 offen nt lds
    buffer_load_dwordx4 v24, s[16:19], s66 offen offset:1024 nt lds
    buffer_load_dwordx4 v24, s[16:19], s66 offen offset:2048 nt lds
    buffer_load_dwordx4 v24, s[16:19], s66 offen offset:3072 nt lds
    s_add_u32 s66, s66, 4096
    s_waitcnt vmcnt(24)
    s_barrier
    s_mov_b32 m0, 0
    s_nop 0
    buffer_load_dwordx4 v24, s[16:19], s66 offen nt lds
    buffer_load_dwordx4 v24, s[16:19], s66 offen offset:1024 nt lds
    buffer_load_dwordx4 v24, s[16:19], s66 offen offset:2048 nt lds
    buffer_load_dwordx4 v24, s[16:19], s66 offen offset:3072 nt lds
    s_add_u32 s66, s66, 4096
    s_mov_b32 m0, 4096
    s_nop 0
    buffer_load_dwordx4 v24, s[16:19], s66 offen nt lds
    buffer_load_dwordx4 v24, s[16:19], s66 offen offset:1024 nt lds
    buffer_load_dwordx4 v24, s[16:19], s66 offen offset:2048 nt lds
    buffer_load_dwordx4 v24, s[16:19], s66 offen offset:3072 nt lds
    s_add_u32 s66, s66, 4096
    s_waitcnt vmcnt(24)
    s_barrier
    s_mov_b32 m0, 8192
    s_nop 0
    buffer_load_dwordx4 v24, s[16:19], s66 offen nt lds
    buffer_load_dwordx4 v24, s[16:19], s66 offen offset:1024 nt lds
    buffer_load_dwordx4 v24, s[16:19], s66 offen offset:2048 nt lds
    buffer_load_dwordx4 v24, s[16:19], s66 offen offset:3072 nt lds
    s_add_u32 s66, s66, 4096
    s_mov_b32 m0, 12288
    s_nop 0
    buffer_load_dwordx4 v24, s[16:19], s66 offen nt lds
    buffer_load_dwordx4 v24, s[16:19], s66 offen offset:1024 nt lds
    buffer_load_dwordx4 v24, s[16:19], s66 offen offset:2048 nt lds
    buffer_load_dwordx4 v24, s[16:19], s66 offen offset:3072 nt lds
    s_add_u32 s66, s66, 4096
    s_add_u32 m0, s88, 0
    s_add_u32 s62, s31, 0
    s_and_b32 s62, s62, 7
    s_lshl_b32 s62, s62, 15
    buffer_load_dwordx4 v12, s[20:23], s62 offen lds
    buffer_load_dwordx4 v13, s[20:23], s62 offen offset:1024 lds
    buffer_load_dwordx4 v14, s[20:23], s62 offen offset:2048 lds
    buffer_load_dwordx4 v15, s[20:23], s62 offen offset:3072 lds
    s_add_u32 m0, s88, 4096
    s_add_u32 s62, s31, 1
    s_and_b32 s62, s62, 7
    s_lshl_b32 s62, s62, 15
    buffer_load_dwordx4 v12, s[20:23], s62 offen lds
    buffer_load_dwordx4 v13, s[20:23], s62 offen offset:1024 lds
    buffer_load_dwordx4 v14, s[20:23], s62 offen offset:2048 lds
    buffer_load_dwordx4 v15, s[20:23], s62 offen offset:3072 lds
    s_waitcnt vmcnt(32)
    s_barrier
    s_add_u32 m0, s89, 0
    s_add_u32 s62, s31, 2
    s_and_b32 s62, s62, 7
    s_lshl_b32 s62, s62, 15
    buffer_load_dwordx4 v12, s[20:23], s62 offen lds
    buffer_load_dwordx4 v13, s[20:23], s62 offen offset:1024 lds
    buffer_load_dwordx4 v14, s[20:23], s62 offen offset:2048 lds
    buffer_load_dwordx4 v15, s[20:23], s62 offen offset:3072 lds
    s_add_u32 m0, s89, 4096
    s_add_u32 s62, s31, 3
    s_and_b32 s62, s62, 7
    s_lshl_b32 s62, s62, 15
    buffer_load_dwordx4 v12, s[20:23], s62 offen lds
    buffer_load_dwordx4 v13, s[20:23], s62 offen offset:1024 lds
    buffer_load_dwordx4 v14, s[20:23], s62 offen offset:2048 lds
    buffer_load_dwordx4 v15, s[20:23], s62 offen offset:3072 lds
    s_waitcnt vmcnt(32)
    s_barrier
    s_waitcnt vmcnt(24)
    s_barrier
    s_add_u32 m0, s90, 0
    s_add_u32 s62, s31, 4
    s_and_b32 s62, s62, 7
    s_lshl_b32 s62, s62, 15
    buffer_load_dwordx4 v12, s[20:23], s62 offen lds
    buffer_load_dwordx4 v13, s[20:23], s62 offen offset:1024 lds
    buffer_load_dwordx4 v14, s[20:23], s62 offen offset:2048 lds
    buffer_load_dwordx4 v15, s[20:23], s62 offen offset:3072 lds
    s_add_u32 m0, s90, 4096
    s_add_u32 s62, s31, 5
    s_and_b32 s62, s62, 7
    s_lshl_b32 s62, s62, 15
    buffer_load_dwordx4 v12, s[20:23], s62 offen lds
    buffer_load_dwordx4 v13, s[20:23], s62 offen offset:1024 lds
    buffer_load_dwordx4 v14, s[20:23], s62 offen offset:2048 lds
    buffer_load_dwordx4 v15, s[20:23], s62 offen offset:3072 lds
    s_waitcnt vmcnt(24)
    s_barrier
    s_barrier
    s_add_u32 m0, s91, 0
    s_add_u32 s62, s31, 6
    s_and_b32 s62, s62, 7
    s_lshl_b32 s62, s62, 15
    buffer_load_dwordx4 v12, s[20:23], s62 offen lds
    buffer_load_dwordx4 v13, s[20:23], s62 offen offset:1024 lds
    buffer_load_dwordx4 v14, s[20:23], s62 offen offset:2048 lds
    buffer_load_dwordx4 v15, s[20:23], s62 offen offset:3072 lds
    s_add_u32 m0, s91, 4096
    s_add_u32 s62, s31, 7
    s_and_b32 s62, s62, 7
    s_lshl_b32 s62, s62, 15
    buffer_load_dwordx4 v12, s[20:23], s62 offen lds
    buffer_load_dwordx4 v13, s[20:23], s62 offen offset:1024 lds
    buffer_load_dwordx4 v14, s[20:23], s62 offen offset:2048 lds
    buffer_load_dwordx4 v15, s[20:23], s62 offen offset:3072 lds
    v_lshlrev_b32 v19, 4, v1
    s_waitcnt vmcnt(16)
    s_barrier
    s_barrier
    s_add_u32 m0, s88, 0
    s_add_u32 s62, s31, 0
    s_and_b32 s62, s62, 7
    s_lshl_b32 s62, s62, 15
    s_add_u32 s62, s62, 128
    buffer_load_dwordx4 v12, s[20:23], s62 offen lds
    buffer_load_dwordx4 v13, s[20:23], s62 offen offset:1024 lds
    buffer_load_dwordx4 v14, s[20:23], s62 offen offset:2048 lds
    buffer_load_dwordx4 v15, s[20:23], s62 offen offset:3072 lds
    s_barrier
    s_add_u32 m0, s88, 4096
    s_add_u32 s62, s31, 1
    s_and_b32 s62, s62, 7
    s_lshl_b32 s62, s62, 15
    s_add_u32 s62, s62, 128
    buffer_load_dwordx4 v12, s[20:23], s62 offen lds
    buffer_load_dwordx4 v13, s[20:23], s62 offen offset:1024 lds
    buffer_load_dwordx4 v14, s[20:23], s62 offen offset:2048 lds
    buffer_load_dwordx4 v15, s[20:23], s62 offen offset:3072 lds
    s_waitcnt vmcnt(16)
    s_barrier
    s_add_u32 m0, s89, 0
    s_add_u32 s62, s31, 2
    s_and_b32 s62, s62, 7
    s_lshl_b32 s62, s62, 15
    s_add_u32 s62, s62, 128
    buffer_load_dwordx4 v12, s[20:23], s62 offen lds
    buffer_load_dwordx4 v13, s[20:23], s62 offen offset:1024 lds
    buffer_load_dwordx4 v14, s[20:23], s62 offen offset:2048 lds
    buffer_load_dwordx4 v15, s[20:23], s62 offen offset:3072 lds
    s_barrier
    s_add_u32 m0, s89, 4096
    s_add_u32 s62, s31, 3
    s_and_b32 s62, s62, 7
    s_lshl_b32 s62, s62, 15
    s_add_u32 s62, s62, 128
    buffer_load_dwordx4 v12, s[20:23], s62 offen lds
    buffer_load_dwordx4 v13, s[20:23], s62 offen offset:1024 lds
    buffer_load_dwordx4 v14, s[20:23], s62 offen offset:2048 lds
    buffer_load_dwordx4 v15, s[20:23], s62 offen offset:3072 lds
    s_waitcnt vmcnt(16)
    s_barrier
    s_add_u32 m0, s90, 0
    s_add_u32 s62, s31, 4
    s_and_b32 s62, s62, 7
    s_lshl_b32 s62, s62, 15
    s_add_u32 s62, s62, 128
    buffer_load_dwordx4 v12, s[20:23], s62 offen lds
    buffer_load_dwordx4 v13, s[20:23], s62 offen offset:1024 lds
    buffer_load_dwordx4 v14, s[20:23], s62 offen offset:2048 lds
    buffer_load_dwordx4 v15, s[20:23], s62 offen offset:3072 lds
    s_barrier
    s_add_u32 m0, s90, 4096
    s_add_u32 s62, s31, 5
    s_and_b32 s62, s62, 7
    s_lshl_b32 s62, s62, 15
    s_add_u32 s62, s62, 128
    buffer_load_dwordx4 v12, s[20:23], s62 offen lds
    buffer_load_dwordx4 v13, s[20:23], s62 offen offset:1024 lds
    buffer_load_dwordx4 v14, s[20:23], s62 offen offset:2048 lds
    buffer_load_dwordx4 v15, s[20:23], s62 offen offset:3072 lds
    s_waitcnt vmcnt(20)
    s_barrier
    s_add_u32 m0, s91, 0
    s_add_u32 s62, s31, 6
    s_and_b32 s62, s62, 7
    s_lshl_b32 s62, s62, 15
    s_add_u32 s62, s62, 128
    buffer_load_dwordx4 v12, s[20:23], s62 offen lds
    buffer_load_dwordx4 v13, s[20:23], s62 offen offset:1024 lds
    buffer_load_dwordx4 v14, s[20:23], s62 offen offset:2048 lds
    buffer_load_dwordx4 v15, s[20:23], s62 offen offset:3072 lds
    s_waitcnt vmcnt(20)
    s_barrier
    s_add_u32 m0, s91, 4096
    s_add_u32 s62, s31, 7
    s_and_b32 s62, s62, 7
    s_lshl_b32 s62, s62, 15
    s_add_u32 s62, s62, 128
    buffer_load_dwordx4 v12, s[20:23], s62 offen lds
    buffer_load_dwordx4 v13, s[20:23], s62 offen offset:1024 lds
    buffer_load_dwordx4 v14, s[20:23], s62 offen offset:2048 lds
    buffer_load_dwordx4 v15, s[20:23], s62 offen offset:3072 lds
    s_waitcnt vmcnt(20)
    s_barrier
    s_waitcnt vmcnt(16)
    s_barrier
    s_waitcnt vmcnt(12)
    s_barrier
    s_waitcnt vmcnt(8)
    s_barrier
    s_waitcnt vmcnt(4)
    s_barrier
    s_waitcnt vmcnt(0)
    s_barrier
    s_barrier
    s_branch L_ld_end
L_ld_end:
    s_endpgm
L_rescale_0:
    s_nop 15
    s_nop 15
    v_max3_f32 v12, v32, v33, v34
    v_max3_f32 v12, v12, v35, v36
    v_max3_f32 v12, v12, v37, v38
    v_max3_f32 v12, v12, v39, v40
    v_max3_f32 v12, v12, v41, v42
    v_max3_f32 v12, v12, v43, v44
    v_max3_f32 v12, v12, v45, v46
    v_max_f32 v12, v12, v47
    v_mov_b32 v13, v12
    s_nop 1
    v_permlane32_swap_b32 v13, v12
    v_max_f32 v12, v12, v13
    v_max_f32 v12, 0, v12
    v_sub_f32 v32, v32, v12
    v_sub_f32 v48, v48, v12
    v_sub_f32 v80, v80, v12
    v_sub_f32 v33, v33, v12
    v_sub_f32 v49, v49, v12
    v_sub_f32 v81, v81, v12
    v_sub_f32 v34, v34, v12
    v_sub_f32 v50, v50, v12
    v_sub_f32 v82, v82, v12
    v_sub_f32 v35, v35, v12
    v_sub_f32 v51, v51, v12
    v_sub_f32 v83, v83, v12
    v_sub_f32 v36, v36, v12
    v_sub_f32 v52, v52, v12
    v_sub_f32 v84, v84, v12
    v_sub_f32 v37, v37, v12
    v_sub_f32 v53, v53, v12
    v_sub_f32 v85, v85, v12
    v_sub_f32 v38, v38, v12
    v_sub_f32 v54, v54, v12
    v_sub_f32 v86, v86, v12
    v_sub_f32 v39, v39, v12
    v_sub_f32 v55, v55, v12
    v_sub_f32 v87, v87, v12
    v_sub_f32 v40, v40, v12
    v_sub_f32 v56, v56, v12
    v_sub_f32 v88, v88, v12
    v_sub_f32 v41, v41, v12
    v_sub_f32 v57, v57, v12
    v_sub_f32 v89, v89, v12
    v_sub_f32 v42, v42, v12
    v_sub_f32 v58, v58, v12
    v_sub_f32 v90, v90, v12
    v_sub_f32 v43, v43, v12
    v_sub_f32 v59, v59, v12
    v_sub_f32 v91, v91, v12
    v_sub_f32 v44, v44, v12
    v_sub_f32 v60, v60, v12
    v_sub_f32 v92, v92, v12
    v_sub_f32 v45, v45, v12
    v_sub_f32 v61, v61, v12
    v_sub_f32 v93, v93, v12
    v_sub_f32 v46, v46, v12
    v_sub_f32 v62, v62, v12
    v_sub_f32 v94, v94, v12
    v_sub_f32 v47, v47, v12
    v_sub_f32 v63, v63, v12
    v_sub_f32 v95, v95, v12
    v_sub_f32 v14, 0, v12
    v_exp_f32 v14, v14
    s_nop 0
    v_mul_f32 v10, v10, v14
    v_mul_f32 v96, v96, v14
    v_mul_f32 v97, v97, v14
    v_mul_f32 v98, v98, v14
    v_mul_f32 v99, v99, v14
    v_mul_f32 v100, v100, v14
    v_mul_f32 v101, v101, v14
    v_mul_f32 v102, v102, v14
    v_mul_f32 v103, v103, v14
    v_mul_f32 v104, v104, v14
    v_mul_f32 v105, v105, v14
    v_mul_f32 v106, v106, v14
    v_mul_f32 v107, v107, v14
    v_mul_f32 v108, v108, v14
    v_mul_f32 v109, v109, v14
    v_mul_f32 v110, v110, v14
    v_mul_f32 v111, v111, v14
    v_mul_f32 v112, v112, v14
    v_mul_f32 v113, v113, v14
    v_mul_f32 v114, v114, v14
    v_mul_f32 v115, v115, v14
    v_mul_f32 v116, v116, v14
    v_mul_f32 v117, v117, v14
    v_mul_f32 v118, v118, v14
    v_mul_f32 v119, v119, v14
    v_mul_f32 v120, v120, v14
    v_mul_f32 v121, v121, v14
    v_mul_f32 v122, v122, v14
    v_mul_f32 v123, v123, v14
    v_mul_f32 v124, v124, v14
    v_mul_f32 v125, v125, v14
    v_mul_f32 v126, v126, v14
    v_mul_f32 v127, v127, v14
    v_mul_f32 v128, v128, v14
    v_mul_f32 v129, v129, v14
    v_mul_f32 v130, v130, v14
    v_mul_f32 v131, v131, v14
    v_mul_f32 v132, v132, v14
    v_mul_f32 v133, v133, v14
    v_mul_f32 v134, v134, v14
    v_mul_f32 v135, v135, v14
    v_mul_f32 v136, v136, v14
    v_mul_f32 v137, v137, v14
    v_mul_f32 v138, v138, v14
    v_mul_f32 v139, v139, v14
    v_mul_f32 v140, v140, v14
    v_mul_f32 v141, v141, v14
    v_mul_f32 v142, v142, v14
    v_mul_f32 v143, v143, v14
    v_mul_f32 v144, v144, v14
    v_mul_f32 v145, v145, v14
    v_mul_f32 v146, v146, v14
    v_mul_f32 v147, v147, v14
    v_mul_f32 v148, v148, v14
    v_mul_f32 v149, v149, v14
    v_mul_f32 v150, v150, v14
    v_mul_f32 v151, v151, v14
    v_mul_f32 v152, v152, v14
    v_mul_f32 v153, v153, v14
    v_mul_f32 v154, v154, v14
    v_mul_f32 v155, v155, v14
    v_mul_f32 v156, v156, v14
    v_mul_f32 v157, v157, v14
    v_mul_f32 v158, v158, v14
    v_mul_f32 v159, v159, v14
    v_exp_f32 v2, v32
    v_exp_f32 v3, v33
    s_nop 0
    v_add_f32 v11, v2, v3
    v_cvt_pk_bf16_f32 v64, v2, v3
    v_exp_f32 v2, v34
    v_exp_f32 v3, v35
    s_nop 0
    v_add_f32 v11, v11, v2
    v_add_f32_e64 v11, v11, v3
    v_cvt_pk_bf16_f32 v65, v2, v3
    v_exp_f32 v2, v36
    v_exp_f32 v3, v37
    s_nop 0
    v_add_f32 v11, v11, v2
    v_add_f32_e64 v11, v11, v3
    v_cvt_pk_bf16_f32 v66, v2, v3
    v_exp_f32 v2, v38
    v_exp_f32 v3, v39
    s_nop 0
    v_add_f32 v11, v11, v2
    v_add_f32_e64 v11, v11, v3
    v_cvt_pk_bf16_f32 v67, v2, v3
    v_exp_f32 v2, v40
    v_exp_f32 v3, v41
    s_nop 0
    v_add_f32 v11, v11, v2
    v_add_f32_e64 v11, v11, v3
    v_cvt_pk_bf16_f32 v68, v2, v3
    v_exp_f32 v2, v42
    v_exp_f32 v3, v43
    s_nop 0
    v_add_f32 v11, v11, v2
    v_add_f32_e64 v11, v11, v3
    v_cvt_pk_bf16_f32 v69, v2, v3
    v_exp_f32 v2, v44
    v_exp_f32 v3, v45
    s_nop 0
    v_add_f32 v11, v11, v2
    v_add_f32_e64 v11, v11, v3
    v_cvt_pk_bf16_f32 v70, v2, v3
    v_exp_f32 v2, v46
    v_exp_f32 v3, v47
    s_nop 0
    v_add_f32 v11, v11, v2
    v_add_f32_e64 v11, v11, v3
    v_cvt_pk_bf16_f32 v71, v2, v3
    s_nop 1
    s_setpc_b64 s[70:71]
L_rescale_1:
    s_nop 15
    s_nop 15
    v_max3_f32 v12, v48, v49, v50
    v_max3_f32 v12, v12, v51, v52
    v_max3_f32 v12, v12, v53, v54
    v_max3_f32 v12, v12, v55, v56
    v_max3_f32 v12, v12, v57, v58
    v_max3_f32 v12, v12, v59, v60
    v_max3_f32 v12, v12, v61, v62
    v_max_f32 v12, v12, v63
    v_mov_b32 v13, v12
    s_nop 1
    v_permlane32_swap_b32 v13, v12
    v_max_f32 v12, v12, v13
    v_max_f32 v12, 0, v12
    v_sub_f32 v48, v48, v12
    v_sub_f32 v32, v32, v12
    v_sub_f32 v80, v80, v12
    v_sub_f32 v49, v49, v12
    v_sub_f32 v33, v33, v12
    v_sub_f32 v81, v81, v12
    v_sub_f32 v50, v50, v12
    v_sub_f32 v34, v34, v12
    v_sub_f32 v82, v82, v12
    v_sub_f32 v51, v51, v12
    v_sub_f32 v35, v35, v12
    v_sub_f32 v83, v83, v12
    v_sub_f32 v52, v52, v12
    v_sub_f32 v36, v36, v12
    v_sub_f32 v84, v84, v12
    v_sub_f32 v53, v53, v12
    v_sub_f32 v37, v37, v12
    v_sub_f32 v85, v85, v12
    v_sub_f32 v54, v54, v12
    v_sub_f32 v38, v38, v12
    v_sub_f32 v86, v86, v12
    v_sub_f32 v55, v55, v12
    v_sub_f32 v39, v39, v12
    v_sub_f32 v87, v87, v12
    v_sub_f32 v56, v56, v12
    v_sub_f32 v40, v40, v12
    v_sub_f32 v88, v88, v12
    v_sub_f32 v57, v57, v12
    v_sub_f32 v41, v41, v12
    v_sub_f32 v89, v89, v12
    v_sub_f32 v58, v58, v12
    v_sub_f32 v42, v42, v12
    v_sub_f32 v90, v90, v12
    v_sub_f32 v59, v59, v12
    v_sub_f32 v43, v43, v12
    v_sub_f32 v91, v91, v12
    v_sub_f32 v60, v60, v12
    v_sub_f32 v44, v44, v12
    v_sub_f32 v92, v92, v12
    v_sub_f32 v61, v61, v12
    v_sub_f32 v45, v45, v12
    v_sub_f32 v93, v93, v12
    v_sub_f32 v62, v62, v12
    v_sub_f32 v46, v46, v12
    v_sub_f32 v94, v94, v12
    v_sub_f32 v63, v63, v12
    v_sub_f32 v47, v47, v12
    v_sub_f32 v95, v95, v12
    v_sub_f32 v14, 0, v12
    v_exp_f32 v14, v14
    s_nop 0
    v_mul_f32 v10, v10, v14
    v_mul_f32 v96, v96, v14
    v_mul_f32 v97, v97, v14
    v_mul_f32 v98, v98, v14
    v_mul_f32 v99, v99, v14
    v_mul_f32 v100, v100, v14
    v_mul_f32 v101, v101, v14
    v_mul_f32 v102, v102, v14
    v_mul_f32 v103, v103, v14
    v_mul_f32 v104, v104, v14
    v_mul_f32 v105, v105, v14
    v_mul_f32 v106, v106, v14
    v_mul_f32 v107, v107, v14
    v_mul_f32 v108, v108, v14
    v_mul_f32 v109, v109, v14
    v_mul_f32 v110, v110, v14
    v_mul_f32 v111, v111, v14
    v_mul_f32 v112, v112, v14
    v_mul_f32 v113, v113, v14
    v_mul_f32 v114, v114, v14
    v_mul_f32 v115, v115, v14
    v_mul_f32 v116, v116, v14
    v_mul_f32 v117, v117, v14
    v_mul_f32 v118, v118, v14
    v_mul_f32 v119, v119, v14
    v_mul_f32 v120, v120, v14
    v_mul_f32 v121, v121, v14
    v_mul_f32 v122, v122, v14
    v_mul_f32 v123, v123, v14
    v_mul_f32 v124, v124, v14
    v_mul_f32 v125, v125, v14
    v_mul_f32 v126, v126, v14
    v_mul_f32 v127, v127, v14
    v_mul_f32 v128, v128, v14
    v_mul_f32 v129, v129, v14
    v_mul_f32 v130, v130, v14
    v_mul_f32 v131, v131, v14
    v_mul_f32 v132, v132, v14
    v_mul_f32 v133, v133, v14
    v_mul_f32 v134, v134, v14
    v_mul_f32 v135, v135, v14
    v_mul_f32 v136, v136, v14
    v_mul_f32 v137, v137, v14
    v_mul_f32 v138, v138, v14
    v_mul_f32 v139, v139, v14
    v_mul_f32 v140, v140, v14
    v_mul_f32 v141, v141, v14
    v_mul_f32 v142, v142, v14
    v_mul_f32 v143, v143, v14
    v_mul_f32 v144, v144, v14
    v_mul_f32 v145, v145, v14
    v_mul_f32 v146, v146, v14
    v_mul_f32 v147, v147, v14
    v_mul_f32 v148, v148, v14
    v_mul_f32 v149, v149, v14
    v_mul_f32 v150, v150, v14
    v_mul_f32 v151, v151, v14
    v_mul_f32 v152, v152, v14
    v_mul_f32 v153, v153, v14
    v_mul_f32 v154, v154, v14
    v_mul_f32 v155, v155, v14
    v_mul_f32 v156, v156, v14
    v_mul_f32 v157, v157, v14
    v_mul_f32 v158, v158, v14
    v_mul_f32 v159, v159, v14
    v_exp_f32 v2, v48
    v_exp_f32 v3, v49
    s_nop 0
    v_add_f32 v11, v2, v3
    v_cvt_pk_bf16_f32 v72, v2, v3
    v_exp_f32 v2, v50
    v_exp_f32 v3, v51
    s_nop 0
    v_add_f32 v11, v11, v2
    v_add_f32_e64 v11, v11, v3
    v_cvt_pk_bf16_f32 v73, v2, v3
    v_exp_f32 v2, v52
    v_exp_f32 v3, v53
    s_nop 0
    v_add_f32 v11, v11, v2
    v_add_f32_e64 v11, v11, v3
    v_cvt_pk_bf16_f32 v74, v2, v3
    v_exp_f32 v2, v54
    v_exp_f32 v3, v55
    s_nop 0
    v_add_f32 v11, v11, v2
    v_add_f32_e64 v11, v11, v3
    v_cvt_pk_bf16_f32 v75, v2, v3
    v_exp_f32 v2, v56
    v_exp_f32 v3, v57
    s_nop 0
    v_add_f32 v11, v11, v2
    v_add_f32_e64 v11, v11, v3
    v_cvt_pk_bf16_f32 v76, v2, v3
    v_exp_f32 v2, v58
    v_exp_f32 v3, v59
    s_nop 0
    v_add_f32 v11, v11, v2
    v_add_f32_e64 v11, v11, v3
    v_cvt_pk_bf16_f32 v77, v2, v3
    v_exp_f32 v2, v60
    v_exp_f32 v3, v61
    s_nop 0
    v_add_f32 v11, v11, v2
    v_add_f32_e64 v11, v11, v3
    v_cvt_pk_bf16_f32 v78, v2, v3
    v_exp_f32 v2, v62
    v_exp_f32 v3, v63
    s_nop 0
    v_add_f32 v11, v11, v2
    v_add_f32_e64 v11, v11, v3
    v_cvt_pk_bf16_f32 v79, v2, v3
    s_nop 1
    s_setpc_b64 s[70:71]
L_rescale_first:
    s_nop 15
    s_nop 15
    v_max3_f32 v12, v32, v33, v34
    v_max3_f32 v12, v12, v35, v36
    v_max3_f32 v12, v12, v37, v38
    v_max3_f32 v12, v12, v39, v40
    v_max3_f32 v12, v12, v41, v42
    v_max3_f32 v12, v12, v43, v44
    v_max3_f32 v12, v12, v45, v46
    v_max_f32 v12, v12, v47
    v_mov_b32 v13, v12
    s_nop 1
    v_permlane32_swap_b32 v13, v12
    v_max_f32 v12, v12, v13
    v_sub_f32 v32, v32, v12
    v_sub_f32 v48, v48, v12
    v_sub_f32 v80, v80, v12
    v_sub_f32 v33, v33, v12
    v_sub_f32 v49, v49, v12
    v_sub_f32 v81, v81, v12
    v_sub_f32 v34, v34, v12
    v_sub_f32 v50, v50, v12
    v_sub_f32 v82, v82, v12
    v_sub_f32 v35, v35, v12
    v_sub_f32 v51, v51, v12
    v_sub_f32 v83, v83, v12
    v_sub_f32 v36, v36, v12
    v_sub_f32 v52, v52, v12
    v_sub_f32 v84, v84, v12
    v_sub_f32 v37, v37, v12
    v_sub_f32 v53, v53, v12
    v_sub_f32 v85, v85, v12
    v_sub_f32 v38, v38, v12
    v_sub_f32 v54, v54, v12
    v_sub_f32 v86, v86, v12
    v_sub_f32 v39, v39, v12
    v_sub_f32 v55, v55, v12
    v_sub_f32 v87, v87, v12
    v_sub_f32 v40, v40, v12
    v_sub_f32 v56, v56, v12
    v_sub_f32 v88, v88, v12
    v_sub_f32 v41, v41, v12
    v_sub_f32 v57, v57, v12
    v_sub_f32 v89, v89, v12
    v_sub_f32 v42, v42, v12
    v_sub_f32 v58, v58, v12
    v_sub_f32 v90, v90, v12
    v_sub_f32 v43, v43, v12
    v_sub_f32 v59, v59, v12
    v_sub_f32 v91, v91, v12
    v_sub_f32 v44, v44, v12
    v_sub_f32 v60, v60, v12
    v_sub_f32 v92, v92, v12
    v_sub_f32 v45, v45, v12
    v_sub_f32 v61, v61, v12
    v_sub_f32 v93, v93, v12
    v_sub_f32 v46, v46, v12
    v_sub_f32 v62, v62, v12
    v_sub_f32 v94, v94, v12
    v_sub_f32 v47, v47, v12
    v_sub_f32 v63, v63, v12
    v_sub_f32 v95, v95, v12
    v_exp_f32 v2, v32
    v_exp_f32 v3, v33
    s_nop 0
    v_add_f32_e64 v11, v2, v3
    v_cvt_pk_bf16_f32 v64, v2, v3
    v_exp_f32 v2, v34
    v_exp_f32 v3, v35
    s_nop 0
    v_add_f32 v11, v11, v2
    v_add_f32_e64 v11, v11, v3
    v_cvt_pk_bf16_f32 v65, v2, v3
    v_exp_f32 v2, v36
    v_exp_f32 v3, v37
    s_nop 0
    v_add_f32 v11, v11, v2
    v_add_f32_e64 v11, v11, v3
    v_cvt_pk_bf16_f32 v66, v2, v3
    v_exp_f32 v2, v38
    v_exp_f32 v3, v39
    s_nop 0
    v_add_f32 v11, v11, v2
    v_add_f32_e64 v11, v11, v3
    v_cvt_pk_bf16_f32 v67, v2, v3
    v_exp_f32 v2, v40
    v_exp_f32 v3, v41
    s_nop 0
    v_add_f32 v11, v11, v2
    v_add_f32_e64 v11, v11, v3
    v_cvt_pk_bf16_f32 v68, v2, v3
    v_exp_f32 v2, v42
    v_exp_f32 v3, v43
    s_nop 0
    v_add_f32 v11, v11, v2
    v_add_f32_e64 v11, v11, v3
    v_cvt_pk_bf16_f32 v69, v2, v3
    v_exp_f32 v2, v44
    v_exp_f32 v3, v45
    s_nop 0
    v_add_f32 v11, v11, v2
    v_add_f32_e64 v11, v11, v3
    v_cvt_pk_bf16_f32 v70, v2, v3
    v_exp_f32 v2, v46
    v_exp_f32 v3, v47
    s_nop 0
    v_add_f32 v11, v11, v2
    v_add_f32_e64 v11, v11, v3
    v_cvt_pk_bf16_f32 v71, v2, v3
    s_nop 1
    s_setpc_b64 s[70:71]
L_rare_0:
    s_call_b64 s[70:71], L_rescale_first
    s_branch L_back_0
L_rare_1:
    s_call_b64 s[70:71], L_rescale_1
    s_branch L_back_1
L_rare_2:
    s_call_b64 s[70:71], L_rescale_0
    s_branch L_back_2
L_rare_3:
    s_call_b64 s[70:71], L_rescale_1
    s_branch L_back_3
L_rare_4:
    s_call_b64 s[70:71], L_rescale_0
    s_branch L_back_4
L_rare_5:
    s_call_b64 s[70:71], L_rescale_1
    s_branch L_back_5
L_rare_6:
    s_call_b64 s[70:71], L_rescale_0
    s_branch L_back_6
L_rare_31:
    s_call_b64 s[70:71], L_rescale_1
    s_branch L_back_31
L_code_end:
.section .rodata,"a"
.p2align 6
.amdhsa_kernel concat_heads__gqa_block_cached__gqa_block_cached__near_ridge_kernel
.amdhsa_next_free_vgpr 256
.amdhsa_next_free_sgpr 102
.amdhsa_accum_offset 160
.amdhsa_group_segment_fixed_size 0
.amdhsa_kernarg_size 104
.amdhsa_user_sgpr_count 2
.amdhsa_user_sgpr_kernarg_segment_ptr 1
.amdhsa_system_sgpr_workgroup_id_x 1
.end_amdhsa_kernel
```
